```python
import torch

def _softmax(x, axis=-1):
    return torch.softmax(x, dim=axis)
def _gelu(x):
    return torch.nn.functional.gelu(x, approximate="tanh")
def _silu(x):
    return torch.nn.functional.silu(x)
def _sigmoid(x):
    return torch.sigmoid(x)
def _layernorm(x, axis=-1, eps=1e-5):
    m = x.mean(dim=axis, keepdim=True)
    v = x.var(dim=axis, keepdim=True, unbiased=False)
    return (x - m) / torch.sqrt(v + eps)
def _scatter_add(tgt, idx, src, axis=0):
    return tgt.clone().index_add_(axis, idx, src)
def _segment_sum(src, seg, n):
    out = torch.zeros((n,) + src.shape[1:], dtype=src.dtype)
    return out.index_add_(0, seg, src)
def _pad(x, pw):
    flat = tuple(v for pair in reversed(pw) for v in pair)
    return torch.nn.functional.pad(x, flat)

kernel_name = 'interleave_layers__ssm_conv_h3__dense_activation_silu__prompt'

def setup_inputs():

    _w = (lambda a: (lambda t: t.to(torch.bfloat16) if t.is_floating_point() else t)(torch.as_tensor(a)))
    def _A_setup():
        B, S, D = 1, 2048, 640
        ks = 4
        return {
            "q": _w((lambda *s: torch.randn(*s, dtype=torch.bfloat16) * 0.05)(B, S, D)),
            "k": _w((lambda *s: torch.randn(*s, dtype=torch.bfloat16) * 0.2)(B, S, D)),
            "v": _w((lambda *s: torch.randn(*s, dtype=torch.bfloat16) * 0.2)(B, S, D)),
            "shift_k": _w((lambda *s: torch.randn(*s, dtype=torch.bfloat16) * 0.2)(D, ks) * 0.5),
            "ssm_k": _w((lambda *s: torch.randn(*s, dtype=torch.bfloat16) * 0.8)(D, S) * (1.0 / S ** 0.5)),
            "ssm_D": _w((lambda *s: torch.randn(*s, dtype=torch.bfloat16) * 0.2)(D)),
        }
    _A_in = _A_setup()

    def _B_setup():
        B, S, D, F = 1, 2048, 640, 1728
        return {
            "x": _w((lambda *s: torch.randn(*s, dtype=torch.bfloat16) * 0.05)(B, S, D)),
            "w1": _w((lambda *s: torch.randn(*s, dtype=torch.bfloat16) * 0.8)(D, F) * (D ** -0.5)),
            "w2": _w((lambda *s: torch.randn(*s, dtype=torch.bfloat16) * 0.2)(F, D) * (F ** -0.5)),
        }
    _B_in = _B_setup()

    return {
        "A_q": _A_in["q"],
        "A_k": _A_in["k"],
        "A_v": _A_in["v"],
        "A_shift_k": _A_in["shift_k"],
        "A_ssm_k": _A_in["ssm_k"],
        "A_ssm_D": _A_in["ssm_D"],
        "B_x": _B_in["x"],
        "B_w1": _B_in["w1"],
        "B_w2": _B_in["w2"],
    }

def reference(A_q, A_k, A_v, A_shift_k, A_ssm_k, A_ssm_D, B_x, B_w1, B_w2):
    def _A_ref(q, k, v, shift_k, ssm_k, ssm_D):
        B, S, D = q.shape
        ks = shift_k.shape[-1]
        k_pad = _pad(k, ((0, 0), (ks - 1, 0), (0, 0)))
        k_shift = torch.zeros_like(k)
        for t in range(ks):
            k_shift = k_shift + k_pad[:, t:t + S, :] * shift_k[:, ks - 1 - t][None, None, :]
        kv = k_shift * v
        L = 2 * S
        kv_pad = _pad(kv, ((0, 0), (0, S), (0, 0)))
        kf_pad = _pad(ssm_k, ((0, 0), (0, S)))
        kv_f = (lambda x, axes=(-2,-1): torch.fft.rfft2(x.float(), dim=axes))(kv_pad[:, None, :, :], axes=(1, 2))
        kf_f = (lambda x, axes=(-2,-1): torch.fft.rfft2(x.float(), dim=axes))(kf_pad[:, None, :], axes=(1, 2))
        kf_f = (lambda x, *d: x.permute(*d))(kf_f, 1, 2, 0)
        y_f = kv_f * kf_f[None, :, :, :]
        y = (lambda x, s, axes=(-2,-1): torch.fft.irfft2(x, s=s, dim=axes).to(torch.bfloat16))(y_f, (1, L), axes=(1, 2))[:, 0, :S, :]
        y = y + kv * ssm_D[None, None, :]
        return q * y

    def _B_ref(x, w1, w2):
        h = torch.einsum("bsd,df->bsf", x, w1)
        h = _silu(h)
        out = torch.einsum("bsf,fd->bsd", h, w2)
        return out

    x = A_q
    x = x + _A_ref(_layernorm(x, axis=-1), A_k, A_v, A_shift_k, A_ssm_k, A_ssm_D)
    x = x + _B_ref(_layernorm(x, axis=-1), B_w1, B_w2)
    x = x + _A_ref(_layernorm(x, axis=-1), A_k, A_v, A_shift_k, A_ssm_k, A_ssm_D)
    x = x + _B_ref(_layernorm(x, axis=-1), B_w1, B_w2)
    return x
```

```asm
; @launch kernel=p_kernel grid=(320,1,1) block=(256,1,1) lds=0
; @launch kernel=c_kernel grid=(1191,1,1) block=(256,1,1) lds=40880
; @launch kernel=f_kernel grid=(256,1,1) block=(256,1,1) lds=163840
.amdgcn_target "amdgcn-amd-amdhsa--gfx950"
.text
.globl p_kernel
.p2align 8
.type p_kernel,@function
p_kernel:
    s_load_dwordx4 s[4:7], s[0:1], 8
    s_load_dwordx2 s[8:9], s[0:1], 24
    s_load_dwordx4 s[12:15], s[0:1], 56
    s_load_dwordx2 s[16:17], s[0:1], 88
    s_cmp_ge_u32 s2, 320
    s_cbranch_scc1 P_done
    s_waitcnt lgkmcnt(0)
    s_cmp_ge_u32 s2, 320
    s_cbranch_scc1 P_poison
    s_mov_b32 s20, s4
    s_mov_b32 s21, s5
    s_and_b32 s21, s21, 0xffff
    s_mov_b32 s22, 2621440
    s_mov_b32 s23, 0x00020000
    s_mov_b32 s24, s6
    s_mov_b32 s25, s7
    s_and_b32 s25, s25, 0xffff
    s_mov_b32 s26, 2621440
    s_mov_b32 s27, 0x00020000
    s_mov_b32 s28, s8
    s_mov_b32 s29, s9
    s_and_b32 s29, s29, 0xffff
    s_mov_b32 s30, 5120
    s_mov_b32 s31, 0x00020000
    s_mov_b32 s32, s16
    s_mov_b32 s33, s17
    s_and_b32 s33, s33, 0xffff
    s_mov_b32 s34, 2621440
    s_mov_b32 s35, 0x00020000
    s_mul_i32 s36, s2, 205
    s_lshr_b32 s36, s36, 11
    s_mul_i32 s37, s36, 10
    s_sub_u32 s37, s2, s37
    v_and_b32 v1, 31, v0
    v_lshrrev_b32 v2, 5, v0
    s_lshl_b32 s38, s37, 6
    v_lshl_add_u32 v3, v1, 1, s38
    s_lshl_b32 s39, s36, 6
    v_lshl_add_u32 v4, v2, 3, s39
    s_movk_i32 s40, 1280
    v_mul_lo_u32 v5, v4, s40
    v_lshl_add_u32 v5, v3, 1, v5
    v_subrev_u32 v6, 3840, v5
    buffer_load_dword v10, v6, s[20:23], 0 offen offset:0
    buffer_load_dword v11, v6, s[20:23], 0 offen offset:1280
    buffer_load_dword v12, v6, s[20:23], 0 offen offset:2560
    buffer_load_dword v13, v5, s[20:23], 0 offen offset:0
    buffer_load_dword v14, v5, s[20:23], 0 offen offset:1280
    buffer_load_dword v15, v5, s[20:23], 0 offen offset:2560
    buffer_load_dword v16, v5, s[20:23], 0 offen offset:3840
    v_add_u32 v7, 5120, v5
    buffer_load_dword v17, v7, s[20:23], 0 offen offset:0
    buffer_load_dword v18, v7, s[20:23], 0 offen offset:1280
    buffer_load_dword v19, v7, s[20:23], 0 offen offset:2560
    buffer_load_dword v20, v7, s[20:23], 0 offen offset:3840
    buffer_load_dword v22, v5, s[24:27], 0 offen offset:0
    buffer_load_dword v23, v5, s[24:27], 0 offen offset:1280
    buffer_load_dword v24, v5, s[24:27], 0 offen offset:2560
    buffer_load_dword v25, v5, s[24:27], 0 offen offset:3840
    buffer_load_dword v26, v7, s[24:27], 0 offen offset:0
    buffer_load_dword v27, v7, s[24:27], 0 offen offset:1280
    buffer_load_dword v28, v7, s[24:27], 0 offen offset:2560
    buffer_load_dword v29, v7, s[24:27], 0 offen offset:3840
    v_lshlrev_b32 v8, 3, v3
    buffer_load_dwordx4 v[32:35], v8, s[28:31], 0 offen
    s_waitcnt vmcnt(0)
    v_lshlrev_b32 v36, 16, v32
    v_and_b32 v37, 0xffff0000, v32
    v_lshlrev_b32 v38, 16, v33
    v_and_b32 v39, 0xffff0000, v33
    v_lshlrev_b32 v40, 16, v34
    v_and_b32 v41, 0xffff0000, v34
    v_lshlrev_b32 v42, 16, v35
    v_and_b32 v43, 0xffff0000, v35
    v_lshlrev_b32 v44, 16, v10
    v_and_b32 v55, 0xffff0000, v10
    v_lshlrev_b32 v45, 16, v11
    v_and_b32 v56, 0xffff0000, v11
    v_lshlrev_b32 v46, 16, v12
    v_and_b32 v57, 0xffff0000, v12
    v_lshlrev_b32 v47, 16, v13
    v_and_b32 v58, 0xffff0000, v13
    v_lshlrev_b32 v48, 16, v14
    v_and_b32 v59, 0xffff0000, v14
    v_lshlrev_b32 v49, 16, v15
    v_and_b32 v60, 0xffff0000, v15
    v_lshlrev_b32 v50, 16, v16
    v_and_b32 v61, 0xffff0000, v16
    v_lshlrev_b32 v51, 16, v17
    v_and_b32 v62, 0xffff0000, v17
    v_lshlrev_b32 v52, 16, v18
    v_and_b32 v63, 0xffff0000, v18
    v_lshlrev_b32 v53, 16, v19
    v_and_b32 v64, 0xffff0000, v19
    v_lshlrev_b32 v54, 16, v20
    v_and_b32 v65, 0xffff0000, v20
    v_mul_f32 v66, v44, v39
    v_mul_f32 v67, v55, v43
    v_cvt_pk_bf16_f32 v68, v66, v67
    v_lshlrev_b32 v86, 16, v68
    v_and_b32 v87, 0xffff0000, v68
    v_mul_f32 v66, v45, v38
    v_mul_f32 v67, v56, v42
    v_cvt_pk_bf16_f32 v68, v66, v67
    v_lshlrev_b32 v66, 16, v68
    v_and_b32 v67, 0xffff0000, v68
    v_add_f32 v66, v86, v66
    v_add_f32 v67, v87, v67
    v_cvt_pk_bf16_f32 v68, v66, v67
    v_lshlrev_b32 v86, 16, v68
    v_and_b32 v87, 0xffff0000, v68
    v_mul_f32 v66, v46, v37
    v_mul_f32 v67, v57, v41
    v_cvt_pk_bf16_f32 v68, v66, v67
    v_lshlrev_b32 v66, 16, v68
    v_and_b32 v67, 0xffff0000, v68
    v_add_f32 v66, v86, v66
    v_add_f32 v67, v87, v67
    v_cvt_pk_bf16_f32 v68, v66, v67
    v_lshlrev_b32 v86, 16, v68
    v_and_b32 v87, 0xffff0000, v68
    v_mul_f32 v66, v47, v36
    v_mul_f32 v67, v58, v40
    v_cvt_pk_bf16_f32 v68, v66, v67
    v_lshlrev_b32 v66, 16, v68
    v_and_b32 v67, 0xffff0000, v68
    v_add_f32 v66, v86, v66
    v_add_f32 v67, v87, v67
    v_cvt_pk_bf16_f32 v68, v66, v67
    v_lshlrev_b32 v86, 16, v68
    v_and_b32 v87, 0xffff0000, v68
    v_lshlrev_b32 v66, 16, v22
    v_and_b32 v67, 0xffff0000, v22
    v_mul_f32 v70, v86, v66
    v_mul_f32 v78, v87, v67
    v_mul_f32 v66, v45, v39
    v_mul_f32 v67, v56, v43
    v_cvt_pk_bf16_f32 v68, v66, v67
    v_lshlrev_b32 v86, 16, v68
    v_and_b32 v87, 0xffff0000, v68
    v_mul_f32 v66, v46, v38
    v_mul_f32 v67, v57, v42
    v_cvt_pk_bf16_f32 v68, v66, v67
    v_lshlrev_b32 v66, 16, v68
    v_and_b32 v67, 0xffff0000, v68
    v_add_f32 v66, v86, v66
    v_add_f32 v67, v87, v67
    v_cvt_pk_bf16_f32 v68, v66, v67
    v_lshlrev_b32 v86, 16, v68
    v_and_b32 v87, 0xffff0000, v68
    v_mul_f32 v66, v47, v37
    v_mul_f32 v67, v58, v41
    v_cvt_pk_bf16_f32 v68, v66, v67
    v_lshlrev_b32 v66, 16, v68
    v_and_b32 v67, 0xffff0000, v68
    v_add_f32 v66, v86, v66
    v_add_f32 v67, v87, v67
    v_cvt_pk_bf16_f32 v68, v66, v67
    v_lshlrev_b32 v86, 16, v68
    v_and_b32 v87, 0xffff0000, v68
    v_mul_f32 v66, v48, v36
    v_mul_f32 v67, v59, v40
    v_cvt_pk_bf16_f32 v68, v66, v67
    v_lshlrev_b32 v66, 16, v68
    v_and_b32 v67, 0xffff0000, v68
    v_add_f32 v66, v86, v66
    v_add_f32 v67, v87, v67
    v_cvt_pk_bf16_f32 v68, v66, v67
    v_lshlrev_b32 v86, 16, v68
    v_and_b32 v87, 0xffff0000, v68
    v_lshlrev_b32 v66, 16, v23
    v_and_b32 v67, 0xffff0000, v23
    v_mul_f32 v71, v86, v66
    v_mul_f32 v79, v87, v67
    v_mul_f32 v66, v46, v39
    v_mul_f32 v67, v57, v43
    v_cvt_pk_bf16_f32 v68, v66, v67
    v_lshlrev_b32 v86, 16, v68
    v_and_b32 v87, 0xffff0000, v68
    v_mul_f32 v66, v47, v38
    v_mul_f32 v67, v58, v42
    v_cvt_pk_bf16_f32 v68, v66, v67
    v_lshlrev_b32 v66, 16, v68
    v_and_b32 v67, 0xffff0000, v68
    v_add_f32 v66, v86, v66
    v_add_f32 v67, v87, v67
    v_cvt_pk_bf16_f32 v68, v66, v67
    v_lshlrev_b32 v86, 16, v68
    v_and_b32 v87, 0xffff0000, v68
    v_mul_f32 v66, v48, v37
    v_mul_f32 v67, v59, v41
    v_cvt_pk_bf16_f32 v68, v66, v67
    v_lshlrev_b32 v66, 16, v68
    v_and_b32 v67, 0xffff0000, v68
    v_add_f32 v66, v86, v66
    v_add_f32 v67, v87, v67
    v_cvt_pk_bf16_f32 v68, v66, v67
    v_lshlrev_b32 v86, 16, v68
    v_and_b32 v87, 0xffff0000, v68
    v_mul_f32 v66, v49, v36
    v_mul_f32 v67, v60, v40
    v_cvt_pk_bf16_f32 v68, v66, v67
    v_lshlrev_b32 v66, 16, v68
    v_and_b32 v67, 0xffff0000, v68
    v_add_f32 v66, v86, v66
    v_add_f32 v67, v87, v67
    v_cvt_pk_bf16_f32 v68, v66, v67
    v_lshlrev_b32 v86, 16, v68
    v_and_b32 v87, 0xffff0000, v68
    v_lshlrev_b32 v66, 16, v24
    v_and_b32 v67, 0xffff0000, v24
    v_mul_f32 v72, v86, v66
    v_mul_f32 v80, v87, v67
    v_mul_f32 v66, v47, v39
    v_mul_f32 v67, v58, v43
    v_cvt_pk_bf16_f32 v68, v66, v67
    v_lshlrev_b32 v86, 16, v68
    v_and_b32 v87, 0xffff0000, v68
    v_mul_f32 v66, v48, v38
    v_mul_f32 v67, v59, v42
    v_cvt_pk_bf16_f32 v68, v66, v67
    v_lshlrev_b32 v66, 16, v68
    v_and_b32 v67, 0xffff0000, v68
    v_add_f32 v66, v86, v66
    v_add_f32 v67, v87, v67
    v_cvt_pk_bf16_f32 v68, v66, v67
    v_lshlrev_b32 v86, 16, v68
    v_and_b32 v87, 0xffff0000, v68
    v_mul_f32 v66, v49, v37
    v_mul_f32 v67, v60, v41
    v_cvt_pk_bf16_f32 v68, v66, v67
    v_lshlrev_b32 v66, 16, v68
    v_and_b32 v67, 0xffff0000, v68
    v_add_f32 v66, v86, v66
    v_add_f32 v67, v87, v67
    v_cvt_pk_bf16_f32 v68, v66, v67
    v_lshlrev_b32 v86, 16, v68
    v_and_b32 v87, 0xffff0000, v68
    v_mul_f32 v66, v50, v36
    v_mul_f32 v67, v61, v40
    v_cvt_pk_bf16_f32 v68, v66, v67
    v_lshlrev_b32 v66, 16, v68
    v_and_b32 v67, 0xffff0000, v68
    v_add_f32 v66, v86, v66
    v_add_f32 v67, v87, v67
    v_cvt_pk_bf16_f32 v68, v66, v67
    v_lshlrev_b32 v86, 16, v68
    v_and_b32 v87, 0xffff0000, v68
    v_lshlrev_b32 v66, 16, v25
    v_and_b32 v67, 0xffff0000, v25
    v_mul_f32 v73, v86, v66
    v_mul_f32 v81, v87, v67
    v_mul_f32 v66, v48, v39
    v_mul_f32 v67, v59, v43
    v_cvt_pk_bf16_f32 v68, v66, v67
    v_lshlrev_b32 v86, 16, v68
    v_and_b32 v87, 0xffff0000, v68
    v_mul_f32 v66, v49, v38
    v_mul_f32 v67, v60, v42
    v_cvt_pk_bf16_f32 v68, v66, v67
    v_lshlrev_b32 v66, 16, v68
    v_and_b32 v67, 0xffff0000, v68
    v_add_f32 v66, v86, v66
    v_add_f32 v67, v87, v67
    v_cvt_pk_bf16_f32 v68, v66, v67
    v_lshlrev_b32 v86, 16, v68
    v_and_b32 v87, 0xffff0000, v68
    v_mul_f32 v66, v50, v37
    v_mul_f32 v67, v61, v41
    v_cvt_pk_bf16_f32 v68, v66, v67
    v_lshlrev_b32 v66, 16, v68
    v_and_b32 v67, 0xffff0000, v68
    v_add_f32 v66, v86, v66
    v_add_f32 v67, v87, v67
    v_cvt_pk_bf16_f32 v68, v66, v67
    v_lshlrev_b32 v86, 16, v68
    v_and_b32 v87, 0xffff0000, v68
    v_mul_f32 v66, v51, v36
    v_mul_f32 v67, v62, v40
    v_cvt_pk_bf16_f32 v68, v66, v67
    v_lshlrev_b32 v66, 16, v68
    v_and_b32 v67, 0xffff0000, v68
    v_add_f32 v66, v86, v66
    v_add_f32 v67, v87, v67
    v_cvt_pk_bf16_f32 v68, v66, v67
    v_lshlrev_b32 v86, 16, v68
    v_and_b32 v87, 0xffff0000, v68
    v_lshlrev_b32 v66, 16, v26
    v_and_b32 v67, 0xffff0000, v26
    v_mul_f32 v74, v86, v66
    v_mul_f32 v82, v87, v67
    v_mul_f32 v66, v49, v39
    v_mul_f32 v67, v60, v43
    v_cvt_pk_bf16_f32 v68, v66, v67
    v_lshlrev_b32 v86, 16, v68
    v_and_b32 v87, 0xffff0000, v68
    v_mul_f32 v66, v50, v38
    v_mul_f32 v67, v61, v42
    v_cvt_pk_bf16_f32 v68, v66, v67
    v_lshlrev_b32 v66, 16, v68
    v_and_b32 v67, 0xffff0000, v68
    v_add_f32 v66, v86, v66
    v_add_f32 v67, v87, v67
    v_cvt_pk_bf16_f32 v68, v66, v67
    v_lshlrev_b32 v86, 16, v68
    v_and_b32 v87, 0xffff0000, v68
    v_mul_f32 v66, v51, v37
    v_mul_f32 v67, v62, v41
    v_cvt_pk_bf16_f32 v68, v66, v67
    v_lshlrev_b32 v66, 16, v68
    v_and_b32 v67, 0xffff0000, v68
    v_add_f32 v66, v86, v66
    v_add_f32 v67, v87, v67
    v_cvt_pk_bf16_f32 v68, v66, v67
    v_lshlrev_b32 v86, 16, v68
    v_and_b32 v87, 0xffff0000, v68
    v_mul_f32 v66, v52, v36
    v_mul_f32 v67, v63, v40
    v_cvt_pk_bf16_f32 v68, v66, v67
    v_lshlrev_b32 v66, 16, v68
    v_and_b32 v67, 0xffff0000, v68
    v_add_f32 v66, v86, v66
    v_add_f32 v67, v87, v67
    v_cvt_pk_bf16_f32 v68, v66, v67
    v_lshlrev_b32 v86, 16, v68
    v_and_b32 v87, 0xffff0000, v68
    v_lshlrev_b32 v66, 16, v27
    v_and_b32 v67, 0xffff0000, v27
    v_mul_f32 v75, v86, v66
    v_mul_f32 v83, v87, v67
    v_mul_f32 v66, v50, v39
    v_mul_f32 v67, v61, v43
    v_cvt_pk_bf16_f32 v68, v66, v67
    v_lshlrev_b32 v86, 16, v68
    v_and_b32 v87, 0xffff0000, v68
    v_mul_f32 v66, v51, v38
    v_mul_f32 v67, v62, v42
    v_cvt_pk_bf16_f32 v68, v66, v67
    v_lshlrev_b32 v66, 16, v68
    v_and_b32 v67, 0xffff0000, v68
    v_add_f32 v66, v86, v66
    v_add_f32 v67, v87, v67
    v_cvt_pk_bf16_f32 v68, v66, v67
    v_lshlrev_b32 v86, 16, v68
    v_and_b32 v87, 0xffff0000, v68
    v_mul_f32 v66, v52, v37
    v_mul_f32 v67, v63, v41
    v_cvt_pk_bf16_f32 v68, v66, v67
    v_lshlrev_b32 v66, 16, v68
    v_and_b32 v67, 0xffff0000, v68
    v_add_f32 v66, v86, v66
    v_add_f32 v67, v87, v67
    v_cvt_pk_bf16_f32 v68, v66, v67
    v_lshlrev_b32 v86, 16, v68
    v_and_b32 v87, 0xffff0000, v68
    v_mul_f32 v66, v53, v36
    v_mul_f32 v67, v64, v40
    v_cvt_pk_bf16_f32 v68, v66, v67
    v_lshlrev_b32 v66, 16, v68
    v_and_b32 v67, 0xffff0000, v68
    v_add_f32 v66, v86, v66
    v_add_f32 v67, v87, v67
    v_cvt_pk_bf16_f32 v68, v66, v67
    v_lshlrev_b32 v86, 16, v68
    v_and_b32 v87, 0xffff0000, v68
    v_lshlrev_b32 v66, 16, v28
    v_and_b32 v67, 0xffff0000, v28
    v_mul_f32 v76, v86, v66
    v_mul_f32 v84, v87, v67
    v_mul_f32 v66, v51, v39
    v_mul_f32 v67, v62, v43
    v_cvt_pk_bf16_f32 v68, v66, v67
    v_lshlrev_b32 v86, 16, v68
    v_and_b32 v87, 0xffff0000, v68
    v_mul_f32 v66, v52, v38
    v_mul_f32 v67, v63, v42
    v_cvt_pk_bf16_f32 v68, v66, v67
    v_lshlrev_b32 v66, 16, v68
    v_and_b32 v67, 0xffff0000, v68
    v_add_f32 v66, v86, v66
    v_add_f32 v67, v87, v67
    v_cvt_pk_bf16_f32 v68, v66, v67
    v_lshlrev_b32 v86, 16, v68
    v_and_b32 v87, 0xffff0000, v68
    v_mul_f32 v66, v53, v37
    v_mul_f32 v67, v64, v41
    v_cvt_pk_bf16_f32 v68, v66, v67
    v_lshlrev_b32 v66, 16, v68
    v_and_b32 v67, 0xffff0000, v68
    v_add_f32 v66, v86, v66
    v_add_f32 v67, v87, v67
    v_cvt_pk_bf16_f32 v68, v66, v67
    v_lshlrev_b32 v86, 16, v68
    v_and_b32 v87, 0xffff0000, v68
    v_mul_f32 v66, v54, v36
    v_mul_f32 v67, v65, v40
    v_cvt_pk_bf16_f32 v68, v66, v67
    v_lshlrev_b32 v66, 16, v68
    v_and_b32 v67, 0xffff0000, v68
    v_add_f32 v66, v86, v66
    v_add_f32 v67, v87, v67
    v_cvt_pk_bf16_f32 v68, v66, v67
    v_lshlrev_b32 v86, 16, v68
    v_and_b32 v87, 0xffff0000, v68
    v_lshlrev_b32 v66, 16, v29
    v_and_b32 v67, 0xffff0000, v29
    v_mul_f32 v77, v86, v66
    v_mul_f32 v85, v87, v67
    v_cvt_pk_bf16_f32 v88, v77, v76
    v_cvt_pk_bf16_f32 v89, v75, v74
    v_cvt_pk_bf16_f32 v90, v73, v72
    v_cvt_pk_bf16_f32 v91, v71, v70
    v_cvt_pk_bf16_f32 v92, v85, v84
    v_cvt_pk_bf16_f32 v93, v83, v82
    v_cvt_pk_bf16_f32 v94, v81, v80
    v_cvt_pk_bf16_f32 v95, v79, v78
    v_lshlrev_b32 v9, 12, v3
    v_sub_u32 v8, 2040, v4
    v_lshl_add_u32 v9, v8, 1, v9
    v_add_u32 v8, 4096, v9
    buffer_store_dwordx4 v[88:91], v9, s[32:35], 0 offen
    buffer_store_dwordx4 v[92:95], v8, s[32:35], 0 offen
    s_endpgm
P_poison:
    s_nop 7
    s_nop 7
    s_mov_b32 s20, s16
    s_mov_b32 s21, s17
    s_and_b32 s21, s21, 0xffff
    s_mov_b32 s22, 41943040
    s_mov_b32 s23, 0x00020000
    s_sub_u32 s36, s2, 320
    s_lshl_b32 s36, s36, 16
    s_add_u32 s37, s36, 9961472
    s_add_u32 s38, s36, 13369344
    s_cmp_lt_u32 s36, 20185088
    s_cselect_b32 s37, s37, s38
    v_lshlrev_b32 v1, 4, v0
    v_mov_b32 v4, -1
    v_mov_b32 v5, -1
    v_mov_b32 v6, -1
    v_mov_b32 v7, -1
    buffer_store_dwordx4 v[4:7], v1, s[20:23], s37 offen
    s_add_u32 s37, s37, 4096
    buffer_store_dwordx4 v[4:7], v1, s[20:23], s37 offen
    s_add_u32 s37, s37, 4096
    buffer_store_dwordx4 v[4:7], v1, s[20:23], s37 offen
    s_add_u32 s37, s37, 4096
    buffer_store_dwordx4 v[4:7], v1, s[20:23], s37 offen
    s_add_u32 s37, s37, 4096
    buffer_store_dwordx4 v[4:7], v1, s[20:23], s37 offen
    s_add_u32 s37, s37, 4096
    buffer_store_dwordx4 v[4:7], v1, s[20:23], s37 offen
    s_add_u32 s37, s37, 4096
    buffer_store_dwordx4 v[4:7], v1, s[20:23], s37 offen
    s_add_u32 s37, s37, 4096
    buffer_store_dwordx4 v[4:7], v1, s[20:23], s37 offen
    s_add_u32 s37, s37, 4096
    buffer_store_dwordx4 v[4:7], v1, s[20:23], s37 offen
    s_add_u32 s37, s37, 4096
    buffer_store_dwordx4 v[4:7], v1, s[20:23], s37 offen
    s_add_u32 s37, s37, 4096
    buffer_store_dwordx4 v[4:7], v1, s[20:23], s37 offen
    s_add_u32 s37, s37, 4096
    buffer_store_dwordx4 v[4:7], v1, s[20:23], s37 offen
    s_add_u32 s37, s37, 4096
    buffer_store_dwordx4 v[4:7], v1, s[20:23], s37 offen
    s_add_u32 s37, s37, 4096
    buffer_store_dwordx4 v[4:7], v1, s[20:23], s37 offen
    s_add_u32 s37, s37, 4096
    buffer_store_dwordx4 v[4:7], v1, s[20:23], s37 offen
    s_add_u32 s37, s37, 4096
    buffer_store_dwordx4 v[4:7], v1, s[20:23], s37 offen
    s_add_u32 s37, s37, 4096
P_done:
    s_endpgm
.globl c_kernel
.p2align 8
.type c_kernel,@function
c_kernel:
    s_cmp_ge_u32 s2, 1191
    s_cbranch_scc1 C_done
    s_load_dwordx4 s[4:7], s[0:1], 32
    s_load_dwordx4 s[12:15], s[0:1], 56
    s_load_dwordx2 s[16:17], s[0:1], 88
    v_lshrrev_b32 v1, 6, v0
    s_nop 0
    v_readfirstlane_b32 s50, v1
    s_waitcnt lgkmcnt(0)
    s_cmp_ge_u32 s2, 640
    s_cbranch_scc1 W_start
    s_lshr_b32 s40, s2, 1
    s_lshl_b32 s40, s40, 2
    s_add_u32 s6, s6, s40
    s_addc_u32 s7, s7, 0
    s_load_dword s41, s[6:7], 0
    s_lshl_b32 s40, s2, 12
    s_add_u32 s20, s4, s40
    s_addc_u32 s21, s5, 0
    s_and_b32 s21, s21, 0xffff
    s_mov_b32 s22, 4096
    s_mov_b32 s23, 0x00020000
    s_add_u32 s24, s16, s40
    s_addc_u32 s25, s17, 0
    s_and_b32 s25, s25, 0xffff
    s_mov_b32 s26, 4096
    s_mov_b32 s27, 0x00020000
    s_add_u32 s28, s16, 7340032
    s_addc_u32 s29, s17, 0
    s_and_b32 s29, s29, 0xffff
    s_mov_b32 s30, 2621440
    s_mov_b32 s31, 0x00020000
    v_lshlrev_b32 v1, 4, v0
    v_subrev_u32 v2, 64, v1
    v_add_u32 v3, 16, v2
    buffer_load_dwordx4 v[32:35], v2, s[20:23], 0 offen
    buffer_load_dwordx4 v[36:39], v3, s[20:23], 0 offen
    buffer_load_dwordx4 v[48:51], v1, s[20:23], 0 offen offset:4032
    buffer_load_dwordx4 v[52:55], v1, s[20:23], 0 offen offset:4048
    buffer_load_dwordx4 v[64:67], v1, s[24:27], 0 offen
    v_lshrrev_b32 v5, 2, v0
    v_mul_u32_u24 v5, 80, v5
    v_and_b32 v6, 3, v0
    v_lshl_add_u32 v5, v6, 4, v5
    v_mov_b32 v8, 0
    v_mov_b32 v9, 0
    v_mov_b32 v10, 0
    v_mov_b32 v11, 0
    v_cmp_gt_u32 vcc, 124, v0
    s_nop 0
    s_and_saveexec_b64 s[42:43], vcc
    ds_write_b128 v5, v[8:11] offset:38400
    s_mov_b64 exec, s[42:43]
    s_waitcnt vmcnt(3)
    v_alignbit_b32 v12, v33, v32, 16
    v_alignbit_b32 v13, v34, v33, 16
    v_alignbit_b32 v14, v35, v34, 16
    v_alignbit_b32 v15, v36, v35, 16
    v_alignbit_b32 v16, v37, v36, 16
    v_alignbit_b32 v17, v38, v37, 16
    v_alignbit_b32 v18, v39, v38, 16
    v_mov_b32 v20, v13
    v_mov_b32 v24, v15
    v_mov_b32 v40, v33
    v_mov_b32 v44, v35
    v_mov_b32 v21, v14
    v_mov_b32 v25, v16
    v_mov_b32 v41, v34
    v_mov_b32 v45, v36
    v_mov_b32 v22, v15
    v_mov_b32 v26, v17
    v_mov_b32 v42, v35
    v_mov_b32 v46, v37
    v_mov_b32 v23, v16
    v_mov_b32 v27, v18
    v_mov_b32 v43, v36
    v_mov_b32 v47, v38
    ds_write_b128 v1, v[12:15] offset:0
    ds_write_b128 v1, v[40:43] offset:4160
    ds_write_b128 v1, v[20:23] offset:8320
    ds_write_b128 v1, v[34:37] offset:12480
    ds_write_b128 v1, v[14:17] offset:16640
    ds_write_b128 v1, v[44:47] offset:20800
    ds_write_b128 v1, v[24:27] offset:24960
    ds_write_b128 v1, v[36:39] offset:29120
    s_waitcnt vmcnt(1)
    v_alignbit_b32 v12, v49, v48, 16
    v_alignbit_b32 v13, v50, v49, 16
    v_alignbit_b32 v14, v51, v50, 16
    v_alignbit_b32 v15, v52, v51, 16
    v_alignbit_b32 v16, v53, v52, 16
    v_alignbit_b32 v17, v54, v53, 16
    v_alignbit_b32 v18, v55, v54, 16
    v_mov_b32 v20, v13
    v_mov_b32 v24, v15
    v_mov_b32 v56, v49
    v_mov_b32 v60, v51
    v_mov_b32 v21, v14
    v_mov_b32 v25, v16
    v_mov_b32 v57, v50
    v_mov_b32 v61, v52
    v_mov_b32 v22, v15
    v_mov_b32 v26, v17
    v_mov_b32 v58, v51
    v_mov_b32 v62, v53
    v_mov_b32 v23, v16
    v_mov_b32 v27, v18
    v_mov_b32 v59, v52
    v_mov_b32 v63, v54
    v_cmp_gt_u32 vcc, 3, v0
    s_nop 0
    s_and_saveexec_b64 s[42:43], vcc
    s_cbranch_execz C_skip1
    ds_write_b128 v1, v[12:15] offset:4096
    ds_write_b128 v1, v[56:59] offset:8256
    ds_write_b128 v1, v[20:23] offset:12416
    ds_write_b128 v1, v[50:53] offset:16576
    ds_write_b128 v1, v[14:17] offset:20736
    ds_write_b128 v1, v[60:63] offset:24896
    ds_write_b128 v1, v[24:27] offset:29056
    ds_write_b128 v1, v[52:55] offset:33216
C_skip1:
    s_mov_b64 exec, s[42:43]
    s_waitcnt vmcnt(0)
    ds_write_b128 v5, v[64:67] offset:33280
    v_and_b32 v7, 63, v0
    v_and_b32 v2, 7, v7
    v_mul_u32_u24 v2, 4160, v2
    v_and_b32 v3, 24, v7
    v_lshl_add_u32 v2, v3, 1, v2
    v_lshrrev_b32 v3, 5, v7
    v_lshl_add_u32 v2, v3, 4, v2
    s_lshl_b32 s44, s50, 9
    v_add_u32 v2, s44, v2
    v_and_b32 v4, 31, v7
    v_sub_u32 v4, 31, v4
    v_mul_u32_u24 v4, 80, v4
    v_lshl_add_u32 v4, v3, 4, v4
    s_mul_i32 s44, s50, 640
    v_add_u32 v4, s44, v4
    s_waitcnt lgkmcnt(0)
    s_barrier
    ds_read_b128 v[32:35], v2 offset:0
    ds_read_b128 v[44:47], v4 offset:35840
    ds_read_b128 v[40:43], v4 offset:33280
    ds_read_b128 v[36:39], v2 offset:2048
    ds_read_b128 v[48:51], v2 offset:32
    ds_read_b128 v[60:63], v4 offset:35872
    ds_read_b128 v[56:59], v4 offset:33312
    ds_read_b128 v[52:55], v2 offset:2080
    ds_read_b128 v[64:67], v2 offset:64
    ds_read_b128 v[76:79], v4 offset:35920
    ds_read_b128 v[72:75], v4 offset:33360
    ds_read_b128 v[68:71], v2 offset:2112
    s_waitcnt lgkmcnt(8)
    v_mfma_f32_32x32x16_bf16 v[128:143], v[32:35], v[44:47], 0
    v_mfma_f32_32x32x16_bf16 v[144:159], v[32:35], v[40:43], 0
    v_mfma_f32_32x32x16_bf16 v[144:159], v[36:39], v[44:47], v[144:159]
    ds_read_b128 v[32:35], v2 offset:96
    ds_read_b128 v[44:47], v4 offset:35952
    ds_read_b128 v[40:43], v4 offset:33392
    ds_read_b128 v[36:39], v2 offset:2144
    s_waitcnt lgkmcnt(8)
    v_mfma_f32_32x32x16_bf16 v[128:143], v[48:51], v[60:63], v[128:143]
    v_mfma_f32_32x32x16_bf16 v[144:159], v[48:51], v[56:59], v[144:159]
    v_mfma_f32_32x32x16_bf16 v[144:159], v[52:55], v[60:63], v[144:159]
    ds_read_b128 v[48:51], v2 offset:128
    ds_read_b128 v[60:63], v4 offset:36000
    ds_read_b128 v[56:59], v4 offset:33440
    ds_read_b128 v[52:55], v2 offset:2176
    s_waitcnt lgkmcnt(8)
    v_mfma_f32_32x32x16_bf16 v[128:143], v[64:67], v[76:79], v[128:143]
    v_mfma_f32_32x32x16_bf16 v[144:159], v[64:67], v[72:75], v[144:159]
    v_mfma_f32_32x32x16_bf16 v[144:159], v[68:71], v[76:79], v[144:159]
    ds_read_b128 v[64:67], v2 offset:160
    ds_read_b128 v[76:79], v4 offset:36032
    ds_read_b128 v[72:75], v4 offset:33472
    ds_read_b128 v[68:71], v2 offset:2208
    s_waitcnt lgkmcnt(8)
    v_mfma_f32_32x32x16_bf16 v[128:143], v[32:35], v[44:47], v[128:143]
    v_mfma_f32_32x32x16_bf16 v[144:159], v[32:35], v[40:43], v[144:159]
    v_mfma_f32_32x32x16_bf16 v[144:159], v[36:39], v[44:47], v[144:159]
    ds_read_b128 v[32:35], v2 offset:192
    ds_read_b128 v[44:47], v4 offset:36080
    ds_read_b128 v[40:43], v4 offset:33520
    ds_read_b128 v[36:39], v2 offset:2240
    s_waitcnt lgkmcnt(8)
    v_mfma_f32_32x32x16_bf16 v[128:143], v[48:51], v[60:63], v[128:143]
    v_mfma_f32_32x32x16_bf16 v[144:159], v[48:51], v[56:59], v[144:159]
    v_mfma_f32_32x32x16_bf16 v[144:159], v[52:55], v[60:63], v[144:159]
    ds_read_b128 v[48:51], v2 offset:224
    ds_read_b128 v[60:63], v4 offset:36112
    ds_read_b128 v[56:59], v4 offset:33552
    ds_read_b128 v[52:55], v2 offset:2272
    s_waitcnt lgkmcnt(8)
    v_mfma_f32_32x32x16_bf16 v[128:143], v[64:67], v[76:79], v[128:143]
    v_mfma_f32_32x32x16_bf16 v[144:159], v[64:67], v[72:75], v[144:159]
    v_mfma_f32_32x32x16_bf16 v[144:159], v[68:71], v[76:79], v[144:159]
    ds_read_b128 v[64:67], v2 offset:256
    ds_read_b128 v[76:79], v4 offset:36160
    ds_read_b128 v[72:75], v4 offset:33600
    ds_read_b128 v[68:71], v2 offset:2304
    s_waitcnt lgkmcnt(8)
    v_mfma_f32_32x32x16_bf16 v[128:143], v[32:35], v[44:47], v[128:143]
    v_mfma_f32_32x32x16_bf16 v[144:159], v[32:35], v[40:43], v[144:159]
    v_mfma_f32_32x32x16_bf16 v[144:159], v[36:39], v[44:47], v[144:159]
    ds_read_b128 v[32:35], v2 offset:288
    ds_read_b128 v[44:47], v4 offset:36192
    ds_read_b128 v[40:43], v4 offset:33632
    ds_read_b128 v[36:39], v2 offset:2336
    s_waitcnt lgkmcnt(8)
    v_mfma_f32_32x32x16_bf16 v[128:143], v[48:51], v[60:63], v[128:143]
    v_mfma_f32_32x32x16_bf16 v[144:159], v[48:51], v[56:59], v[144:159]
    v_mfma_f32_32x32x16_bf16 v[144:159], v[52:55], v[60:63], v[144:159]
    ds_read_b128 v[48:51], v2 offset:320
    ds_read_b128 v[60:63], v4 offset:36240
    ds_read_b128 v[56:59], v4 offset:33680
    ds_read_b128 v[52:55], v2 offset:2368
    s_waitcnt lgkmcnt(8)
    v_mfma_f32_32x32x16_bf16 v[128:143], v[64:67], v[76:79], v[128:143]
    v_mfma_f32_32x32x16_bf16 v[144:159], v[64:67], v[72:75], v[144:159]
    v_mfma_f32_32x32x16_bf16 v[144:159], v[68:71], v[76:79], v[144:159]
    ds_read_b128 v[64:67], v2 offset:352
    ds_read_b128 v[76:79], v4 offset:36272
    ds_read_b128 v[72:75], v4 offset:33712
    ds_read_b128 v[68:71], v2 offset:2400
    s_waitcnt lgkmcnt(8)
    v_mfma_f32_32x32x16_bf16 v[128:143], v[32:35], v[44:47], v[128:143]
    v_mfma_f32_32x32x16_bf16 v[144:159], v[32:35], v[40:43], v[144:159]
    v_mfma_f32_32x32x16_bf16 v[144:159], v[36:39], v[44:47], v[144:159]
    ds_read_b128 v[32:35], v2 offset:384
    ds_read_b128 v[44:47], v4 offset:36320
    ds_read_b128 v[40:43], v4 offset:33760
    ds_read_b128 v[36:39], v2 offset:2432
    s_waitcnt lgkmcnt(8)
    v_mfma_f32_32x32x16_bf16 v[128:143], v[48:51], v[60:63], v[128:143]
    v_mfma_f32_32x32x16_bf16 v[144:159], v[48:51], v[56:59], v[144:159]
    v_mfma_f32_32x32x16_bf16 v[144:159], v[52:55], v[60:63], v[144:159]
    ds_read_b128 v[48:51], v2 offset:416
    ds_read_b128 v[60:63], v4 offset:36352
    ds_read_b128 v[56:59], v4 offset:33792
    ds_read_b128 v[52:55], v2 offset:2464
    s_waitcnt lgkmcnt(8)
    v_mfma_f32_32x32x16_bf16 v[128:143], v[64:67], v[76:79], v[128:143]
    v_mfma_f32_32x32x16_bf16 v[144:159], v[64:67], v[72:75], v[144:159]
    v_mfma_f32_32x32x16_bf16 v[144:159], v[68:71], v[76:79], v[144:159]
    ds_read_b128 v[64:67], v2 offset:448
    ds_read_b128 v[76:79], v4 offset:36400
    ds_read_b128 v[72:75], v4 offset:33840
    ds_read_b128 v[68:71], v2 offset:2496
    s_waitcnt lgkmcnt(8)
    v_mfma_f32_32x32x16_bf16 v[128:143], v[32:35], v[44:47], v[128:143]
    v_mfma_f32_32x32x16_bf16 v[144:159], v[32:35], v[40:43], v[144:159]
    v_mfma_f32_32x32x16_bf16 v[144:159], v[36:39], v[44:47], v[144:159]
    ds_read_b128 v[32:35], v2 offset:480
    ds_read_b128 v[44:47], v4 offset:36432
    ds_read_b128 v[40:43], v4 offset:33872
    ds_read_b128 v[36:39], v2 offset:2528
    s_waitcnt lgkmcnt(8)
    v_mfma_f32_32x32x16_bf16 v[128:143], v[48:51], v[60:63], v[128:143]
    v_mfma_f32_32x32x16_bf16 v[144:159], v[48:51], v[56:59], v[144:159]
    v_mfma_f32_32x32x16_bf16 v[144:159], v[52:55], v[60:63], v[144:159]
    s_waitcnt lgkmcnt(4)
    v_mfma_f32_32x32x16_bf16 v[128:143], v[64:67], v[76:79], v[128:143]
    v_mfma_f32_32x32x16_bf16 v[144:159], v[64:67], v[72:75], v[144:159]
    v_mfma_f32_32x32x16_bf16 v[144:159], v[68:71], v[76:79], v[144:159]
    s_waitcnt lgkmcnt(0)
    v_mfma_f32_32x32x16_bf16 v[128:143], v[32:35], v[44:47], v[128:143]
    v_mfma_f32_32x32x16_bf16 v[144:159], v[32:35], v[40:43], v[144:159]
    v_mfma_f32_32x32x16_bf16 v[144:159], v[36:39], v[44:47], v[144:159]
    s_barrier
    v_lshlrev_b32 v8, 4, v7
    s_lshl_b32 s44, s50, 13
    v_add_u32 v9, s44, v8
    s_nop 5
    ds_write_b128 v9, v[128:131] offset:0
    ds_write_b128 v9, v[132:135] offset:1024
    ds_write_b128 v9, v[136:139] offset:2048
    ds_write_b128 v9, v[140:143] offset:3072
    ds_write_b128 v9, v[144:147] offset:4096
    ds_write_b128 v9, v[148:151] offset:5120
    ds_write_b128 v9, v[152:155] offset:6144
    ds_write_b128 v9, v[156:159] offset:7168
    s_waitcnt lgkmcnt(0)
    s_barrier
    s_lshl_b32 s44, s50, 11
    v_add_u32 v9, s44, v8
    ds_read_b128 v[32:35], v9 offset:0
    ds_read_b128 v[36:39], v9 offset:1024
    ds_read_b128 v[40:43], v9 offset:8192
    ds_read_b128 v[44:47], v9 offset:9216
    ds_read_b128 v[48:51], v9 offset:16384
    ds_read_b128 v[52:55], v9 offset:17408
    ds_read_b128 v[56:59], v9 offset:24576
    ds_read_b128 v[60:63], v9 offset:25600
    s_and_b32 s40, s2, 1
    s_lshl_b32 s40, s40, 4
    s_lshr_b32 s41, s41, s40
    s_lshl_b32 s41, s41, 16
    s_lshr_b32 s44, s50, 1
    s_and_b32 s45, s50, 1
    s_lshl_b32 s45, s45, 1
    v_and_b32 v5, 31, v7
    v_lshrrev_b32 v6, 5, v7
    v_sub_u32 v10, 63, v5
    v_mul_u32_u24 v10, 80, v10
    v_lshlrev_b32 v11, 3, v6
    v_sub_u32 v10, v10, v11
    s_mul_i32 s46, s44, 2560
    s_lshl_b32 s47, s45, 4
    s_add_u32 s46, s46, s47
    v_subrev_u32 v10, s46, v10
    ds_read_b64 v[70:71], v10 offset:33336
    ds_read_b64 v[72:73], v10 offset:33320
    s_mov_b32 s40, 40960
    v_mul_lo_u32 v12, v5, s40
    s_lshl_b32 s42, s2, 4
    s_mul_i32 s46, s44, 1310720
    s_mul_i32 s47, s45, 10240
    s_add_u32 s42, s42, s46
    s_add_u32 s42, s42, s47
    v_add_u32 v12, v12, v11
    s_waitcnt lgkmcnt(0)
    v_add_f32 v32, v32, v40
    v_add_f32 v48, v48, v56
    v_add_f32 v33, v33, v41
    v_add_f32 v49, v49, v57
    v_add_f32 v34, v34, v42
    v_add_f32 v50, v50, v58
    v_add_f32 v35, v35, v43
    v_add_f32 v51, v51, v59
    v_add_f32 v32, v32, v48
    v_add_f32 v33, v33, v49
    v_add_f32 v34, v34, v50
    v_add_f32 v35, v35, v51
    v_add_f32 v36, v36, v44
    v_add_f32 v52, v52, v60
    v_add_f32 v37, v37, v45
    v_add_f32 v53, v53, v61
    v_add_f32 v38, v38, v46
    v_add_f32 v54, v54, v62
    v_add_f32 v39, v39, v47
    v_add_f32 v55, v55, v63
    v_add_f32 v36, v36, v52
    v_add_f32 v37, v37, v53
    v_add_f32 v38, v38, v54
    v_add_f32 v39, v39, v55
    v_and_b32 v80, 0xffff0000, v71
    v_lshlrev_b32 v81, 16, v71
    v_and_b32 v82, 0xffff0000, v70
    v_lshlrev_b32 v83, 16, v70
    v_mul_f32 v80, s41, v80
    v_mul_f32 v81, s41, v81
    v_mul_f32 v82, s41, v82
    v_mul_f32 v83, s41, v83
    v_cvt_pk_bf16_f32 v84, v80, v81
    v_cvt_pk_bf16_f32 v85, v82, v83
    v_cvt_pk_bf16_f32 v86, v32, v33
    v_cvt_pk_bf16_f32 v87, v34, v35
    v_lshlrev_b32 v80, 16, v84
    v_and_b32 v81, 0xffff0000, v84
    v_lshlrev_b32 v82, 16, v85
    v_and_b32 v83, 0xffff0000, v85
    v_lshlrev_b32 v88, 16, v86
    v_and_b32 v89, 0xffff0000, v86
    v_lshlrev_b32 v90, 16, v87
    v_and_b32 v91, 0xffff0000, v87
    v_add_f32 v80, v80, v88
    v_add_f32 v81, v81, v89
    v_add_f32 v82, v82, v90
    v_add_f32 v83, v83, v91
    v_cvt_pk_bf16_f32 v92, v80, v81
    v_cvt_pk_bf16_f32 v93, v82, v83
    buffer_store_dwordx2 v[92:93], v12, s[28:31], s42 offen
    s_add_u32 s42, s42, 10240
    v_and_b32 v80, 0xffff0000, v73
    v_lshlrev_b32 v81, 16, v73
    v_and_b32 v82, 0xffff0000, v72
    v_lshlrev_b32 v83, 16, v72
    v_mul_f32 v80, s41, v80
    v_mul_f32 v81, s41, v81
    v_mul_f32 v82, s41, v82
    v_mul_f32 v83, s41, v83
    v_cvt_pk_bf16_f32 v84, v80, v81
    v_cvt_pk_bf16_f32 v85, v82, v83
    v_cvt_pk_bf16_f32 v86, v36, v37
    v_cvt_pk_bf16_f32 v87, v38, v39
    v_lshlrev_b32 v80, 16, v84
    v_and_b32 v81, 0xffff0000, v84
    v_lshlrev_b32 v82, 16, v85
    v_and_b32 v83, 0xffff0000, v85
    v_lshlrev_b32 v88, 16, v86
    v_and_b32 v89, 0xffff0000, v86
    v_lshlrev_b32 v90, 16, v87
    v_and_b32 v91, 0xffff0000, v87
    v_add_f32 v80, v80, v88
    v_add_f32 v81, v81, v89
    v_add_f32 v82, v82, v90
    v_add_f32 v83, v83, v91
    v_cvt_pk_bf16_f32 v94, v80, v81
    v_cvt_pk_bf16_f32 v95, v82, v83
    buffer_store_dwordx2 v[94:95], v12, s[28:31], s42 offen
    s_add_u32 s42, s42, 10240
C_done:
    s_endpgm
W_start:
    s_nop 7
    s_nop 7
    s_cmp_ge_u32 s2, 920
    s_cbranch_scc1 W_not_w1
    s_mov_b32 s20, s12
    s_mov_b32 s21, s13
    s_and_b32 s21, s21, 0xffff
    s_mov_b32 s22, 2211840
    s_mov_b32 s23, 0x00020000
    s_add_u32 s24, s16, 2621440
    s_addc_u32 s25, s17, 0
    s_and_b32 s25, s25, 0xffff
    s_mov_b32 s26, 2293760
    s_mov_b32 s27, 0x00020000
    s_sub_u32 s36, s2, 640
    s_mul_i32 s37, s36, 293
    s_lshr_b32 s37, s37, 11
    s_mul_i32 s38, s37, 7
    s_sub_u32 s38, s36, s38
    v_and_b32 v1, 127, v0
    s_lshl_b32 s39, s38, 7
    v_add_u32 v1, s39, v1
    v_lshrrev_b32 v2, 7, v0
    s_lshl_b32 s39, s37, 1
    v_add_u32 v2, s39, v2
    v_lshlrev_b32 v3, 1, v1
    s_movk_i32 s40, 27648
    v_mul_lo_u32 v4, v2, s40
    v_lshl_add_u32 v4, v3, 1, v4
    v_mov_b32 v5, 0x7ff00000
    v_cmp_gt_u32 vcc, 1728, v3
    s_nop 1
    v_cndmask_b32 v4, v5, v4, vcc
    buffer_load_dword v10, v4, s[20:23], 0 offen
    v_add_u32 v21, 3456, v4
    buffer_load_dword v11, v21, s[20:23], 0 offen
    v_add_u32 v22, 6912, v4
    buffer_load_dword v12, v22, s[20:23], 0 offen
    v_add_u32 v23, 10368, v4
    buffer_load_dword v13, v23, s[20:23], 0 offen
    v_add_u32 v24, 13824, v4
    buffer_load_dword v14, v24, s[20:23], 0 offen
    v_add_u32 v25, 17280, v4
    buffer_load_dword v15, v25, s[20:23], 0 offen
    v_add_u32 v26, 20736, v4
    buffer_load_dword v16, v26, s[20:23], 0 offen
    v_add_u32 v27, 24192, v4
    buffer_load_dword v17, v27, s[20:23], 0 offen
    v_lshrrev_b32 v5, 4, v3
    v_mul_u32_u24 v6, 147, v5
    v_lshrrev_b32 v6, 10, v6
    v_mul_u32_u24 v7, 7, v6
    v_sub_u32 v7, v5, v7
    v_lshrrev_b32 v8, 2, v2
    v_and_b32 v9, 3, v2
    v_mul_u32_u24 v6, 20, v6
    v_add_u32 v6, v6, v8
    v_mul_u32_u24 v6, 7, v6
    v_add_u32 v6, v6, v7
    v_lshlrev_b32 v6, 6, v6
    v_lshl_add_u32 v6, v9, 4, v6
    v_and_b32 v7, 15, v3
    v_add_u32 v6, v6, v7
    v_lshlrev_b32 v6, 4, v6
    s_mov_b32 s40, 0x05040100
    s_mov_b32 s41, 0x07060302
    s_waitcnt vmcnt(0)
    v_perm_b32 v32, v11, v10, s40
    v_perm_b32 v36, v11, v10, s41
    v_perm_b32 v33, v13, v12, s40
    v_perm_b32 v37, v13, v12, s41
    v_perm_b32 v34, v15, v14, s40
    v_perm_b32 v38, v15, v14, s41
    v_perm_b32 v35, v17, v16, s40
    v_perm_b32 v39, v17, v16, s41
    buffer_store_dwordx4 v[32:35], v6, s[24:27], 0 offen
    buffer_store_dwordx4 v[36:39], v6, s[24:27], 0 offen offset:16
    s_endpgm
W_not_w1:
    s_nop 7
    s_nop 7
    s_cmp_ge_u32 s2, 1190
    s_cbranch_scc1 W_flags
    s_mov_b32 s20, s14
    s_mov_b32 s21, s15
    s_and_b32 s21, s21, 0xffff
    s_mov_b32 s22, 2211840
    s_mov_b32 s23, 0x00020000
    s_add_u32 s24, s16, 4980736
    s_addc_u32 s25, s17, 0
    s_and_b32 s25, s25, 0xffff
    s_mov_b32 s26, 2211840
    s_mov_b32 s27, 0x00020000
    s_sub_u32 s36, s2, 920
    s_mul_i32 s37, s36, 205
    s_lshr_b32 s37, s37, 10
    s_mul_i32 s38, s37, 5
    s_sub_u32 s38, s36, s38
    v_and_b32 v1, 63, v0
    s_lshl_b32 s39, s38, 6
    v_add_u32 v1, s39, v1
    v_lshlrev_b32 v3, 1, v1
    v_lshrrev_b32 v9, 6, v0
    s_lshl_b32 s39, s37, 5
    v_lshl_add_u32 v2, v9, 2, s39
    s_movk_i32 s40, 1280
    v_mul_lo_u32 v4, v2, s40
    v_lshl_add_u32 v4, v3, 1, v4
    v_add_u32 v5, 20480, v4
    buffer_load_dword v10, v4, s[20:23], 0 offen offset:0
    buffer_load_dword v11, v4, s[20:23], 0 offen offset:1280
    buffer_load_dword v12, v4, s[20:23], 0 offen offset:2560
    buffer_load_dword v13, v4, s[20:23], 0 offen offset:3840
    buffer_load_dword v14, v5, s[20:23], 0 offen offset:0
    buffer_load_dword v15, v5, s[20:23], 0 offen offset:1280
    buffer_load_dword v16, v5, s[20:23], 0 offen offset:2560
    buffer_load_dword v17, v5, s[20:23], 0 offen offset:3840
    v_lshrrev_b32 v5, 4, v3
    v_mul_u32_u24 v6, 205, v5
    v_lshrrev_b32 v6, 10, v6
    v_mul_u32_u24 v7, 5, v6
    v_sub_u32 v7, v5, v7
    v_mul_u32_u24 v6, 54, v6
    v_add_u32 v6, s37, v6
    v_mul_u32_u24 v6, 5, v6
    v_add_u32 v6, v6, v7
    v_lshlrev_b32 v6, 6, v6
    v_lshl_add_u32 v6, v9, 4, v6
    v_and_b32 v7, 15, v3
    v_add_u32 v6, v6, v7
    v_lshlrev_b32 v6, 4, v6
    s_mov_b32 s40, 0x05040100
    s_mov_b32 s41, 0x07060302
    s_waitcnt vmcnt(0)
    v_perm_b32 v32, v11, v10, s40
    v_perm_b32 v36, v11, v10, s41
    v_perm_b32 v33, v13, v12, s40
    v_perm_b32 v37, v13, v12, s41
    v_perm_b32 v34, v15, v14, s40
    v_perm_b32 v38, v15, v14, s41
    v_perm_b32 v35, v17, v16, s40
    v_perm_b32 v39, v17, v16, s41
    buffer_store_dwordx4 v[32:35], v6, s[24:27], 0 offen
    buffer_store_dwordx4 v[36:39], v6, s[24:27], 0 offen offset:16
    s_endpgm
W_flags:
    s_nop 7
    s_nop 7
    s_add_u32 s24, s16, 30408704
    s_addc_u32 s25, s17, 0
    s_and_b32 s25, s25, 0xffff
    s_mov_b32 s26, 32768
    s_mov_b32 s27, 0x00020000
    v_lshlrev_b32 v1, 4, v0
    v_mov_b32 v4, 0
    v_mov_b32 v5, 0
    v_mov_b32 v6, 0
    v_mov_b32 v7, 0
    v_add_u32 v8, 0, v1
    buffer_store_dwordx4 v[4:7], v8, s[24:27], 0 offen
    v_add_u32 v9, 4096, v1
    buffer_store_dwordx4 v[4:7], v9, s[24:27], 0 offen
    v_add_u32 v10, 8192, v1
    buffer_store_dwordx4 v[4:7], v10, s[24:27], 0 offen
    v_add_u32 v11, 12288, v1
    buffer_store_dwordx4 v[4:7], v11, s[24:27], 0 offen
    v_add_u32 v12, 16384, v1
    buffer_store_dwordx4 v[4:7], v12, s[24:27], 0 offen
    v_add_u32 v13, 20480, v1
    buffer_store_dwordx4 v[4:7], v13, s[24:27], 0 offen
    v_add_u32 v14, 24576, v1
    buffer_store_dwordx4 v[4:7], v14, s[24:27], 0 offen
    v_add_u32 v15, 28672, v1
    buffer_store_dwordx4 v[4:7], v15, s[24:27], 0 offen
    s_endpgm
.globl f_kernel
.p2align 8
.type f_kernel,@function
f_kernel:
    s_cmp_ge_u32 s2, 256
    s_cbranch_scc1 F_done
    s_load_dwordx2 s[4:5], s[0:1], 0
    s_load_dwordx2 s[6:7], s[0:1], 72
    s_load_dwordx2 s[16:17], s[0:1], 88
    s_and_b32 s10, s2, 7
    s_lshr_b32 s11, s2, 3
    s_lshl_b32 s12, s10, 1
    s_lshr_b32 s13, s11, 4
    s_add_u32 s48, s12, s13
    s_and_b32 s49, s11, 15
    v_lshrrev_b32 v10, 6, v0
    s_nop 0
    v_readfirstlane_b32 s50, v10
    s_waitcnt lgkmcnt(0)
    s_mov_b32 s20, s4
    s_mov_b32 s21, s5
    s_and_b32 s21, s21, 0xffff
    s_mov_b32 s22, 2621440
    s_mov_b32 s23, 0x00020000
    s_mov_b32 s24, s16
    s_mov_b32 s25, s17
    s_and_b32 s25, s25, 0xffff
    s_mov_b32 s26, 41943040
    s_mov_b32 s27, 0x00020000
    s_add_u32 s28, s16, 17825792
    s_addc_u32 s29, s17, 0
    s_and_b32 s29, s29, 0xffff
    s_mov_b32 s30, 2621440
    s_mov_b32 s31, 0x00020000
    s_mov_b32 s51, 0
    s_mov_b32 s36, 0xbfb8aa3b
    s_mov_b32 s37, 0xbfb8aa3b
    s_mov_b32 s38, 1.0
    s_mov_b32 s39, 1.0
    s_mov_b32 s52, 15204352
    s_mov_b32 s53, 9961472
    s_mov_b32 s54, 23068672
    s_lshl_b32 s56, s48, 7
    s_add_u32 s56, s56, 30408704
    s_getreg_b32 s19, hwreg(HW_REG_XCC_ID, 0, 4)
    s_add_u32 s19, s19, 1
    s_lshl_b32 s57, s49, 2
    s_add_u32 s57, s57, s56
    s_add_u32 s57, s57, 12288
    v_mov_b32 v12, 0
    v_mov_b32 v13, s19
    s_mov_b64 exec, 1
    buffer_store_dword v13, v12, s[24:27], s57 offen sc1
    s_mov_b64 exec, -1
    s_mul_i32 s64, s50, 14
    s_cmp_eq_u32 s50, 3
    s_cselect_b32 s65, 1, 0
    s_sub_u32 s64, s64, s65
    s_and_b32 s65, s49, 7
    s_mul_i32 s65, s65, 54
    s_add_u32 s65, s65, s64
    s_mul_i32 s65, s65, 5120
    s_add_u32 s65, s65, 4980736
    s_mul_i32 s68, s50, 35840
    s_mul_i32 s69, s49, 143360
    s_add_u32 s69, s69, s68
    s_add_u32 s69, s69, 2621440
    v_lshrrev_b32 v10, 5, v0
    v_and_b32 v11, 31, v0
    v_mul_u32_u24 v1, 1280, v10
    v_lshl_add_u32 v1, v11, 3, v1
    v_lshlrev_b32 v2, 4, v0
    v_add_u32 v3, 4096, v2
    v_add_u32 v4, 8192, v2
    v_and_b32 v5, 0xfc, v0
    v_add_u32 v6, v2, v5
    v_add_u32 v6, 143360, v6
    v_mul_u32_u24 v7, 68, v11
    v_lshl_add_u32 v7, v10, 1, v7
    v_add_u32 v7, 143360, v7
    v_lshrrev_b32 v12, 3, v11
    v_lshlrev_b32 v8, 10, v12
    v_bfe_u32 v12, v11, 1, 2
    v_lshl_add_u32 v8, v12, 8, v8
    v_lshl_add_u32 v8, v10, 4, v8
    v_and_b32 v12, 1, v11
    v_lshl_add_u32 v8, v12, 3, v8
    v_and_b32 v12, 63, v0
    v_lshlrev_b32 v9, 4, v12
F_layer:
    s_nop 7
    s_nop 7
    s_lshl_b32 s60, s48, 4
    s_add_u32 s60, s60, s49
    s_mul_i32 s61, s60, 10240
    s_add_u32 s62, s61, 7340032
    buffer_load_dwordx2 v[64:65], v1, s[20:23], s61 offen offset:0 sc1 nt
    buffer_load_dwordx2 v[66:67], v1, s[20:23], s61 offen offset:256 sc1 nt
    buffer_load_dwordx2 v[68:69], v1, s[20:23], s61 offen offset:512 sc1 nt
    buffer_load_dwordx2 v[70:71], v1, s[20:23], s61 offen offset:768 sc1 nt
    buffer_load_dwordx2 v[72:73], v1, s[20:23], s61 offen offset:1024 sc1 nt
    buffer_load_dwordx4 v[76:79], v2, s[24:27], s62 offen
    buffer_load_dwordx4 v[80:83], v3, s[24:27], s62 offen
    buffer_load_dwordx4 v[84:87], v4, s[24:27], s62 offen
    s_cmp_lg_u32 s51, 0
    s_cbranch_scc1 F_l1
    s_add_u32 s57, s56, 12288
    v_and_b32 v12, 15, v0
    v_lshlrev_b32 v12, 2, v12
    s_mov_b32 s58, 0
    buffer_load_dword v13, v12, s[24:27], s57 offen sc1
    s_mov_b32 m0, s68
    s_nop 0
    buffer_load_dwordx4 v9, s[24:27], s69 offen offset:0 lds
    buffer_load_dwordx4 v9, s[24:27], s69 offen offset:1024 lds
    buffer_load_dwordx4 v9, s[24:27], s69 offen offset:2048 lds
    buffer_load_dwordx4 v9, s[24:27], s69 offen offset:3072 lds
    s_add_u32 s68, s68, 4096
    s_add_u32 s69, s69, 4096
    s_mov_b32 m0, s68
    s_nop 0
    buffer_load_dwordx4 v9, s[24:27], s69 offen offset:0 lds
    buffer_load_dwordx4 v9, s[24:27], s69 offen offset:1024 lds
    buffer_load_dwordx4 v9, s[24:27], s69 offen offset:2048 lds
    buffer_load_dwordx4 v9, s[24:27], s69 offen offset:3072 lds
    s_add_u32 s68, s68, 4096
    s_add_u32 s69, s69, 4096
    s_mov_b32 m0, s68
    s_nop 0
    buffer_load_dwordx4 v9, s[24:27], s69 offen offset:0 lds
    buffer_load_dwordx4 v9, s[24:27], s69 offen offset:1024 lds
    buffer_load_dwordx4 v9, s[24:27], s69 offen offset:2048 lds
    buffer_load_dwordx4 v9, s[24:27], s69 offen offset:3072 lds
    s_add_u32 s68, s68, 4096
    s_add_u32 s69, s69, 4096
    s_waitcnt vmcnt(12)
F_id_poll:
    v_cmp_eq_u32 vcc, 0, v13
    s_nop 1
    s_cmp_eq_u64 vcc, 0
    s_cbranch_scc1 F_id_ok
    s_sleep 1
    buffer_load_dword v13, v12, s[24:27], s57 offen sc1
    s_waitcnt vmcnt(0)
    s_add_u32 s58, s58, 1
    s_cmp_lt_u32 s58, 200000
    s_cbranch_scc1 F_id_poll
F_id_ok:
    v_cmp_ne_u32 vcc, s19, v13
    s_nop 1
    s_cmp_eq_u64 vcc, 0
    s_cselect_b32 s19, 1, 0
    ds_write_b32 v6, v76 offset:0
    ds_write_b32 v6, v80 offset:4352
    ds_write_b32 v6, v77 offset:4
    ds_write_b32 v6, v81 offset:4356
    ds_write_b32 v6, v78 offset:8
    ds_write_b32 v6, v82 offset:4360
    ds_write_b32 v6, v79 offset:12
    ds_write_b32 v6, v83 offset:4364
    s_cmp_ge_u32 s50, 2
    s_cbranch_scc1 F_skipwa
    ds_write_b32 v6, v84 offset:8704
    ds_write_b32 v6, v85 offset:8708
    ds_write_b32 v6, v86 offset:8712
    ds_write_b32 v6, v87 offset:8716
F_skipwa:
    v_mov_b32 v90, 0
    v_mov_b32 v91, 0
    v_mov_b32 v92, 0
    v_mov_b32 v93, 0
    v_mov_b32 v94, 0
    v_mov_b32 v95, 0
    v_mov_b32 v96, 0
    s_mov_b32 m0, s68
    s_nop 0
    buffer_load_dwordx4 v9, s[24:27], s69 offen offset:0 lds
    v_mov_b32 v97, 0
    v_mov_b32 v98, 0
    v_mov_b32 v99, 0
    v_mov_b32 v100, 0
    v_mov_b32 v101, 0
    v_mov_b32 v102, 0
    v_mov_b32 v103, 0
    buffer_load_dwordx4 v9, s[24:27], s69 offen offset:1024 lds
    v_mov_b32 v104, 0
    v_mov_b32 v105, 0
    v_mov_b32 v106, 0
    v_mov_b32 v107, 0
    v_mov_b32 v108, 0
    v_mov_b32 v109, 0
    v_lshlrev_b32 v110, 16, v64
    buffer_load_dwordx4 v9, s[24:27], s69 offen offset:2048 lds
    v_and_b32 v111, 0xffff0000, v64
    v_lshlrev_b32 v112, 16, v65
    v_and_b32 v113, 0xffff0000, v65
    v_lshlrev_b32 v114, 16, v66
    v_and_b32 v115, 0xffff0000, v66
    v_lshlrev_b32 v116, 16, v67
    v_and_b32 v117, 0xffff0000, v67
    buffer_load_dwordx4 v9, s[24:27], s69 offen offset:3072 lds
    s_add_u32 s68, s68, 4096
    s_add_u32 s69, s69, 4096
    v_lshlrev_b32 v118, 16, v68
    v_and_b32 v119, 0xffff0000, v68
    v_lshlrev_b32 v120, 16, v69
    v_and_b32 v121, 0xffff0000, v69
    v_lshlrev_b32 v122, 16, v70
    v_and_b32 v123, 0xffff0000, v70
    v_lshlrev_b32 v124, 16, v71
    s_mov_b32 m0, s68
    s_nop 0
    buffer_load_dwordx4 v9, s[24:27], s69 offen offset:0 lds
    v_and_b32 v125, 0xffff0000, v71
    v_lshlrev_b32 v126, 16, v72
    v_and_b32 v127, 0xffff0000, v72
    v_lshlrev_b32 v128, 16, v73
    v_and_b32 v129, 0xffff0000, v73
    s_waitcnt lgkmcnt(0)
    s_barrier
    ds_read_u16_d16_hi v90, v7 offset:0
    ds_read_u16_d16_hi v91, v7 offset:16
    ds_read_u16_d16_hi v92, v7 offset:32
    ds_read_u16_d16_hi v93, v7 offset:48
    ds_read_u16_d16_hi v94, v7 offset:2176
    ds_read_u16_d16_hi v95, v7 offset:2192
    ds_read_u16_d16_hi v96, v7 offset:2208
    ds_read_u16_d16_hi v97, v7 offset:2224
    ds_read_u16_d16_hi v98, v7 offset:4352
    ds_read_u16_d16_hi v99, v7 offset:4368
    ds_read_u16_d16_hi v100, v7 offset:4384
    ds_read_u16_d16_hi v101, v7 offset:4400
    ds_read_u16_d16_hi v102, v7 offset:6528
    ds_read_u16_d16_hi v103, v7 offset:6544
    ds_read_u16_d16_hi v104, v7 offset:6560
    ds_read_u16_d16_hi v105, v7 offset:6576
    ds_read_u16_d16_hi v106, v7 offset:8704
    ds_read_u16_d16_hi v107, v7 offset:8720
    ds_read_u16_d16_hi v108, v7 offset:8736
    ds_read_u16_d16_hi v109, v7 offset:8752
    v_pk_add_f32 v[134:135], v[110:111], v[112:113]
    v_pk_add_f32 v[136:137], v[114:115], v[116:117]
    buffer_load_dwordx4 v9, s[24:27], s69 offen offset:1024 lds
    v_pk_add_f32 v[134:135], v[134:135], v[118:119]
    v_pk_add_f32 v[136:137], v[136:137], v[120:121]
    v_pk_add_f32 v[134:135], v[134:135], v[122:123]
    v_pk_add_f32 v[136:137], v[136:137], v[124:125]
    v_pk_add_f32 v[134:135], v[134:135], v[126:127]
    v_pk_add_f32 v[136:137], v[136:137], v[128:129]
    v_pk_add_f32 v[134:135], v[134:135], v[136:137]
    buffer_load_dwordx4 v9, s[24:27], s69 offen offset:2048 lds
    v_add_f32 v134, v134, v135
    s_nop 1
    v_add_f32_dpp v132, v134, v134 row_ror:1 row_mask:0xf bank_mask:0xf
    v_mov_b32 v134, v132
    s_nop 1
    v_add_f32_dpp v132, v134, v134 row_ror:2 row_mask:0xf bank_mask:0xf
    v_mov_b32 v134, v132
    s_nop 1
    v_add_f32_dpp v132, v134, v134 row_ror:4 row_mask:0xf bank_mask:0xf
    v_mov_b32 v134, v132
    buffer_load_dwordx4 v9, s[24:27], s69 offen offset:3072 lds
    s_add_u32 s68, s68, 4096
    s_add_u32 s69, s69, 4096
    v_add_f32_dpp v132, v134, v134 row_ror:8 row_mask:0xf bank_mask:0xf
    v_mov_b32 v134, v132
    v_mov_b32 v133, v134
    s_nop 1
    v_permlane16_swap_b32 v132, v133
    v_add_f32 v134, v132, v133
    v_mul_f32 v134, 0x3acccccd, v134
    v_pk_add_f32 v[132:133], v[110:111], v[134:135] op_sel_hi:[1,0] neg_lo:[0,1] neg_hi:[0,1]
    s_mov_b32 m0, s68
    s_nop 0
    buffer_load_dwordx4 v9, s[24:27], s69 offen offset:0 lds
    v_pk_add_f32 v[130:131], v[112:113], v[134:135] op_sel_hi:[1,0] neg_lo:[0,1] neg_hi:[0,1]
    v_pk_mul_f32 v[136:137], v[132:133], v[132:133]
    v_pk_mul_f32 v[138:139], v[130:131], v[130:131]
    v_pk_add_f32 v[132:133], v[114:115], v[134:135] op_sel_hi:[1,0] neg_lo:[0,1] neg_hi:[0,1]
    v_pk_add_f32 v[130:131], v[116:117], v[134:135] op_sel_hi:[1,0] neg_lo:[0,1] neg_hi:[0,1]
    v_pk_fma_f32 v[136:137], v[132:133], v[132:133], v[136:137]
    v_pk_fma_f32 v[138:139], v[130:131], v[130:131], v[138:139]
    buffer_load_dwordx4 v9, s[24:27], s69 offen offset:1024 lds
    v_pk_add_f32 v[132:133], v[118:119], v[134:135] op_sel_hi:[1,0] neg_lo:[0,1] neg_hi:[0,1]
    v_pk_add_f32 v[130:131], v[120:121], v[134:135] op_sel_hi:[1,0] neg_lo:[0,1] neg_hi:[0,1]
    v_pk_fma_f32 v[136:137], v[132:133], v[132:133], v[136:137]
    v_pk_fma_f32 v[138:139], v[130:131], v[130:131], v[138:139]
    v_pk_add_f32 v[132:133], v[122:123], v[134:135] op_sel_hi:[1,0] neg_lo:[0,1] neg_hi:[0,1]
    v_pk_add_f32 v[130:131], v[124:125], v[134:135] op_sel_hi:[1,0] neg_lo:[0,1] neg_hi:[0,1]
    v_pk_fma_f32 v[136:137], v[132:133], v[132:133], v[136:137]
    buffer_load_dwordx4 v9, s[24:27], s69 offen offset:2048 lds
    v_pk_fma_f32 v[138:139], v[130:131], v[130:131], v[138:139]
    v_pk_add_f32 v[132:133], v[126:127], v[134:135] op_sel_hi:[1,0] neg_lo:[0,1] neg_hi:[0,1]
    v_pk_add_f32 v[130:131], v[128:129], v[134:135] op_sel_hi:[1,0] neg_lo:[0,1] neg_hi:[0,1]
    v_pk_fma_f32 v[136:137], v[132:133], v[132:133], v[136:137]
    v_pk_fma_f32 v[138:139], v[130:131], v[130:131], v[138:139]
    v_pk_add_f32 v[136:137], v[136:137], v[138:139]
    v_add_f32 v131, v136, v137
    buffer_load_dwordx4 v9, s[24:27], s69 offen offset:3072 lds
    s_add_u32 s68, s68, 4096
    s_add_u32 s69, s69, 4096
    v_add_f32_dpp v132, v131, v131 row_ror:1 row_mask:0xf bank_mask:0xf
    v_mov_b32 v131, v132
    s_nop 1
    v_add_f32_dpp v132, v131, v131 row_ror:2 row_mask:0xf bank_mask:0xf
    v_mov_b32 v131, v132
    s_nop 1
    v_add_f32_dpp v132, v131, v131 row_ror:4 row_mask:0xf bank_mask:0xf
    v_mov_b32 v131, v132
    s_nop 1
    v_add_f32_dpp v132, v131, v131 row_ror:8 row_mask:0xf bank_mask:0xf
    s_mov_b32 m0, s68
    s_nop 0
    buffer_load_dwordx4 v9, s[24:27], s69 offen offset:0 lds
    v_mov_b32 v131, v132
    v_mov_b32 v133, v131
    s_nop 1
    v_permlane16_swap_b32 v132, v133
    v_add_f32 v131, v132, v133
    v_mul_f32 v131, 0x3acccccd, v131
    v_cvt_pk_bf16_f32 v132, v134, v134
    v_lshlrev_b32 v130, 16, v132
    buffer_load_dwordx4 v9, s[24:27], s69 offen offset:1024 lds
    v_cvt_pk_bf16_f32 v133, v131, v131
    v_lshlrev_b32 v131, 16, v133
    v_add_f32 v131, 0x3727c5ac, v131
    v_cvt_pk_bf16_f32 v132, v131, v131
    v_lshlrev_b32 v131, 16, v132
    v_sqrt_f32 v131, v131
    s_nop 0
    v_cvt_pk_bf16_f32 v132, v131, v131
    buffer_load_dwordx4 v9, s[24:27], s69 offen offset:2048 lds
    v_lshlrev_b32 v131, 16, v132
    v_rcp_f32 v131, v131
    s_waitcnt lgkmcnt(0)
    v_pk_add_f32 v[140:141], v[110:111], v[130:131] op_sel_hi:[1,0] neg_lo:[0,1] neg_hi:[0,1]
    v_pk_add_f32 v[144:145], v[112:113], v[130:131] op_sel_hi:[1,0] neg_lo:[0,1] neg_hi:[0,1]
    v_pk_add_f32 v[148:149], v[114:115], v[130:131] op_sel_hi:[1,0] neg_lo:[0,1] neg_hi:[0,1]
    v_pk_add_f32 v[152:153], v[116:117], v[130:131] op_sel_hi:[1,0] neg_lo:[0,1] neg_hi:[0,1]
    v_pk_add_f32 v[156:157], v[118:119], v[130:131] op_sel_hi:[1,0] neg_lo:[0,1] neg_hi:[0,1]
    buffer_load_dwordx4 v9, s[24:27], s69 offen offset:3072 lds
    s_add_u32 s68, s68, 4096
    s_add_u32 s69, s69, 4096
    v_cvt_pk_bf16_f32 v142, v140, v141
    v_cvt_pk_bf16_f32 v146, v144, v145
    v_cvt_pk_bf16_f32 v150, v148, v149
    v_cvt_pk_bf16_f32 v154, v152, v153
    v_cvt_pk_bf16_f32 v158, v156, v157
    v_lshlrev_b32 v140, 16, v142
    v_lshlrev_b32 v144, 16, v146
    s_mov_b32 m0, s68
    s_nop 0
    buffer_load_dwordx4 v9, s[24:27], s69 offen offset:0 lds
    v_lshlrev_b32 v148, 16, v150
    v_lshlrev_b32 v152, 16, v154
    v_lshlrev_b32 v156, 16, v158
    v_and_b32 v141, 0xffff0000, v142
    v_and_b32 v145, 0xffff0000, v146
    v_and_b32 v149, 0xffff0000, v150
    v_and_b32 v153, 0xffff0000, v154
    buffer_load_dwordx4 v9, s[24:27], s69 offen offset:1024 lds
    v_and_b32 v157, 0xffff0000, v158
    v_pk_mul_f32 v[140:141], v[140:141], v[130:131] op_sel:[0,1] op_sel_hi:[1,1]
    v_pk_mul_f32 v[144:145], v[144:145], v[130:131] op_sel:[0,1] op_sel_hi:[1,1]
    v_pk_mul_f32 v[148:149], v[148:149], v[130:131] op_sel:[0,1] op_sel_hi:[1,1]
    v_pk_mul_f32 v[152:153], v[152:153], v[130:131] op_sel:[0,1] op_sel_hi:[1,1]
    v_pk_mul_f32 v[156:157], v[156:157], v[130:131] op_sel:[0,1] op_sel_hi:[1,1]
    v_cvt_pk_bf16_f32 v142, v140, v141
    buffer_load_dwordx4 v9, s[24:27], s69 offen offset:2048 lds
    v_cvt_pk_bf16_f32 v146, v144, v145
    v_cvt_pk_bf16_f32 v150, v148, v149
    v_cvt_pk_bf16_f32 v154, v152, v153
    v_cvt_pk_bf16_f32 v158, v156, v157
    v_lshlrev_b32 v140, 16, v142
    v_lshlrev_b32 v144, 16, v146
    v_lshlrev_b32 v148, 16, v150
    buffer_load_dwordx4 v9, s[24:27], s69 offen offset:3072 lds
    s_add_u32 s68, s68, 4096
    s_add_u32 s69, s69, 4096
    v_lshlrev_b32 v152, 16, v154
    v_lshlrev_b32 v156, 16, v158
    v_and_b32 v141, 0xffff0000, v142
    v_and_b32 v145, 0xffff0000, v146
    v_and_b32 v149, 0xffff0000, v150
    v_and_b32 v153, 0xffff0000, v154
    v_and_b32 v157, 0xffff0000, v158
    s_mov_b32 m0, s68
    s_nop 0
    buffer_load_dwordx4 v9, s[24:27], s69 offen offset:0 lds
    v_pk_mul_f32 v[140:141], v[140:141], v[90:91]
    v_pk_mul_f32 v[144:145], v[144:145], v[92:93]
    v_pk_mul_f32 v[148:149], v[148:149], v[94:95]
    v_pk_mul_f32 v[152:153], v[152:153], v[96:97]
    v_pk_mul_f32 v[156:157], v[156:157], v[98:99]
    v_cvt_pk_bf16_f32 v142, v140, v141
    v_cvt_pk_bf16_f32 v146, v144, v145
    buffer_load_dwordx4 v9, s[24:27], s69 offen offset:1024 lds
    v_cvt_pk_bf16_f32 v150, v148, v149
    v_cvt_pk_bf16_f32 v154, v152, v153
    v_cvt_pk_bf16_f32 v158, v156, v157
    v_lshlrev_b32 v140, 16, v142
    v_lshlrev_b32 v144, 16, v146
    v_lshlrev_b32 v148, 16, v150
    v_lshlrev_b32 v152, 16, v154
    buffer_load_dwordx4 v9, s[24:27], s69 offen offset:2048 lds
    v_lshlrev_b32 v156, 16, v158
    v_and_b32 v141, 0xffff0000, v142
    v_and_b32 v145, 0xffff0000, v146
    v_and_b32 v149, 0xffff0000, v150
    v_and_b32 v153, 0xffff0000, v154
    v_and_b32 v157, 0xffff0000, v158
    v_pk_add_f32 v[140:141], v[110:111], v[140:141]
    buffer_load_dwordx4 a[0:3], v9, s[24:27], s65 offen offset:0
    v_pk_add_f32 v[144:145], v[112:113], v[144:145]
    v_pk_add_f32 v[148:149], v[114:115], v[148:149]
    v_pk_add_f32 v[152:153], v[116:117], v[152:153]
    v_pk_add_f32 v[156:157], v[118:119], v[156:157]
    v_cvt_pk_bf16_f32 v64, v140, v141
    v_cvt_pk_bf16_f32 v65, v144, v145
    v_cvt_pk_bf16_f32 v66, v148, v149
    buffer_load_dwordx4 a[4:7], v9, s[24:27], s65 offen offset:1024
    v_cvt_pk_bf16_f32 v67, v152, v153
    v_cvt_pk_bf16_f32 v68, v156, v157
    v_lshlrev_b32 v110, 16, v64
    v_lshlrev_b32 v112, 16, v65
    v_lshlrev_b32 v114, 16, v66
    v_lshlrev_b32 v116, 16, v67
    v_lshlrev_b32 v118, 16, v68
    buffer_load_dwordx4 a[8:11], v9, s[24:27], s65 offen offset:2048
    v_and_b32 v111, 0xffff0000, v64
    v_and_b32 v113, 0xffff0000, v65
    v_and_b32 v115, 0xffff0000, v66
    v_and_b32 v117, 0xffff0000, v67
    v_and_b32 v119, 0xffff0000, v68
    v_pk_add_f32 v[140:141], v[120:121], v[130:131] op_sel_hi:[1,0] neg_lo:[0,1] neg_hi:[0,1]
    v_pk_add_f32 v[144:145], v[122:123], v[130:131] op_sel_hi:[1,0] neg_lo:[0,1] neg_hi:[0,1]
    buffer_load_dwordx4 a[12:15], v9, s[24:27], s65 offen offset:3072
    s_add_u32 s65, s65, 4096
    v_pk_add_f32 v[148:149], v[124:125], v[130:131] op_sel_hi:[1,0] neg_lo:[0,1] neg_hi:[0,1]
    v_pk_add_f32 v[152:153], v[126:127], v[130:131] op_sel_hi:[1,0] neg_lo:[0,1] neg_hi:[0,1]
    v_pk_add_f32 v[156:157], v[128:129], v[130:131] op_sel_hi:[1,0] neg_lo:[0,1] neg_hi:[0,1]
    v_cvt_pk_bf16_f32 v142, v140, v141
    v_cvt_pk_bf16_f32 v146, v144, v145
    v_cvt_pk_bf16_f32 v150, v148, v149
    v_cvt_pk_bf16_f32 v154, v152, v153
    buffer_load_dwordx4 a[16:19], v9, s[24:27], s65 offen offset:0
    v_cvt_pk_bf16_f32 v158, v156, v157
    v_lshlrev_b32 v140, 16, v142
    v_lshlrev_b32 v144, 16, v146
    v_lshlrev_b32 v148, 16, v150
    v_lshlrev_b32 v152, 16, v154
    v_lshlrev_b32 v156, 16, v158
    v_and_b32 v141, 0xffff0000, v142
    buffer_load_dwordx4 a[20:23], v9, s[24:27], s65 offen offset:1024
    v_and_b32 v145, 0xffff0000, v146
    v_and_b32 v149, 0xffff0000, v150
    v_and_b32 v153, 0xffff0000, v154
    v_and_b32 v157, 0xffff0000, v158
    v_pk_mul_f32 v[140:141], v[140:141], v[130:131] op_sel:[0,1] op_sel_hi:[1,1]
    v_pk_mul_f32 v[144:145], v[144:145], v[130:131] op_sel:[0,1] op_sel_hi:[1,1]
    v_pk_mul_f32 v[148:149], v[148:149], v[130:131] op_sel:[0,1] op_sel_hi:[1,1]
    buffer_load_dwordx4 a[24:27], v9, s[24:27], s65 offen offset:2048
    v_pk_mul_f32 v[152:153], v[152:153], v[130:131] op_sel:[0,1] op_sel_hi:[1,1]
    v_pk_mul_f32 v[156:157], v[156:157], v[130:131] op_sel:[0,1] op_sel_hi:[1,1]
    v_cvt_pk_bf16_f32 v142, v140, v141
    v_cvt_pk_bf16_f32 v146, v144, v145
    v_cvt_pk_bf16_f32 v150, v148, v149
    v_cvt_pk_bf16_f32 v154, v152, v153
    v_cvt_pk_bf16_f32 v158, v156, v157
    buffer_load_dwordx4 a[28:31], v9, s[24:27], s65 offen offset:3072
    s_add_u32 s65, s65, 4096
    v_lshlrev_b32 v140, 16, v142
    v_lshlrev_b32 v144, 16, v146
    v_lshlrev_b32 v148, 16, v150
    v_lshlrev_b32 v152, 16, v154
    v_lshlrev_b32 v156, 16, v158
    v_and_b32 v141, 0xffff0000, v142
    v_and_b32 v145, 0xffff0000, v146
    buffer_load_dwordx4 a[32:35], v9, s[24:27], s65 offen offset:0
    v_and_b32 v149, 0xffff0000, v150
    v_and_b32 v153, 0xffff0000, v154
    v_and_b32 v157, 0xffff0000, v158
    v_pk_mul_f32 v[140:141], v[140:141], v[100:101]
    v_pk_mul_f32 v[144:145], v[144:145], v[102:103]
    v_pk_mul_f32 v[148:149], v[148:149], v[104:105]
    v_pk_mul_f32 v[152:153], v[152:153], v[106:107]
    buffer_load_dwordx4 a[36:39], v9, s[24:27], s65 offen offset:1024
    v_pk_mul_f32 v[156:157], v[156:157], v[108:109]
    v_cvt_pk_bf16_f32 v142, v140, v141
    v_cvt_pk_bf16_f32 v146, v144, v145
    v_cvt_pk_bf16_f32 v150, v148, v149
    v_cvt_pk_bf16_f32 v154, v152, v153
    v_cvt_pk_bf16_f32 v158, v156, v157
    v_lshlrev_b32 v140, 16, v142
    buffer_load_dwordx4 a[40:43], v9, s[24:27], s65 offen offset:2048
    v_lshlrev_b32 v144, 16, v146
    v_lshlrev_b32 v148, 16, v150
    v_lshlrev_b32 v152, 16, v154
    v_lshlrev_b32 v156, 16, v158
    v_and_b32 v141, 0xffff0000, v142
    v_and_b32 v145, 0xffff0000, v146
    v_and_b32 v149, 0xffff0000, v150
    buffer_load_dwordx4 a[44:47], v9, s[24:27], s65 offen offset:3072
    s_add_u32 s65, s65, 4096
    v_and_b32 v153, 0xffff0000, v154
    v_and_b32 v157, 0xffff0000, v158
    v_pk_add_f32 v[140:141], v[120:121], v[140:141]
    v_pk_add_f32 v[144:145], v[122:123], v[144:145]
    v_pk_add_f32 v[148:149], v[124:125], v[148:149]
    v_pk_add_f32 v[152:153], v[126:127], v[152:153]
    v_pk_add_f32 v[156:157], v[128:129], v[156:157]
    buffer_load_dwordx4 a[48:51], v9, s[24:27], s65 offen offset:0
    v_cvt_pk_bf16_f32 v69, v140, v141
    v_cvt_pk_bf16_f32 v70, v144, v145
    v_cvt_pk_bf16_f32 v71, v148, v149
    v_cvt_pk_bf16_f32 v72, v152, v153
    v_cvt_pk_bf16_f32 v73, v156, v157
    v_lshlrev_b32 v120, 16, v69
    v_lshlrev_b32 v122, 16, v70
    buffer_load_dwordx4 a[52:55], v9, s[24:27], s65 offen offset:1024
    v_lshlrev_b32 v124, 16, v71
    v_lshlrev_b32 v126, 16, v72
    v_lshlrev_b32 v128, 16, v73
    v_and_b32 v121, 0xffff0000, v69
    v_and_b32 v123, 0xffff0000, v70
    v_and_b32 v125, 0xffff0000, v71
    v_and_b32 v127, 0xffff0000, v72
    buffer_load_dwordx4 a[56:59], v9, s[24:27], s65 offen offset:2048
    v_and_b32 v129, 0xffff0000, v73
    s_add_u32 s62, s61, s52
    s_cmp_eq_u32 s19, 0
    s_cbranch_scc1 D_slow3
    buffer_store_dwordx2 v[64:65], v1, s[24:27], s62 offen offset:0
    buffer_store_dwordx2 v[66:67], v1, s[24:27], s62 offen offset:256
    buffer_store_dwordx2 v[68:69], v1, s[24:27], s62 offen offset:512
    buffer_store_dwordx2 v[70:71], v1, s[24:27], s62 offen offset:768
    buffer_store_dwordx2 v[72:73], v1, s[24:27], s62 offen offset:1024
    s_branch D_end3
D_slow3:
    buffer_store_dwordx2 v[64:65], v1, s[24:27], s62 offen offset:0 sc1
    buffer_store_dwordx2 v[66:67], v1, s[24:27], s62 offen offset:256 sc1
    buffer_store_dwordx2 v[68:69], v1, s[24:27], s62 offen offset:512 sc1
    buffer_store_dwordx2 v[70:71], v1, s[24:27], s62 offen offset:768 sc1
    buffer_store_dwordx2 v[72:73], v1, s[24:27], s62 offen offset:1024 sc1
D_end3:
    v_pk_add_f32 v[134:135], v[110:111], v[112:113]
    v_pk_add_f32 v[136:137], v[114:115], v[116:117]
    v_pk_add_f32 v[134:135], v[134:135], v[118:119]
    v_pk_add_f32 v[136:137], v[136:137], v[120:121]
    v_pk_add_f32 v[134:135], v[134:135], v[122:123]
    v_pk_add_f32 v[136:137], v[136:137], v[124:125]
    buffer_load_dwordx4 a[60:63], v9, s[24:27], s65 offen offset:3072
    s_add_u32 s65, s65, 4096
    v_pk_add_f32 v[134:135], v[134:135], v[126:127]
    v_pk_add_f32 v[136:137], v[136:137], v[128:129]
    v_pk_add_f32 v[134:135], v[134:135], v[136:137]
    v_add_f32 v134, v134, v135
    s_nop 1
    v_add_f32_dpp v132, v134, v134 row_ror:1 row_mask:0xf bank_mask:0xf
    v_mov_b32 v134, v132
    s_nop 1
    v_add_f32_dpp v132, v134, v134 row_ror:2 row_mask:0xf bank_mask:0xf
    buffer_load_dwordx4 a[64:67], v9, s[24:27], s65 offen offset:0
    v_mov_b32 v134, v132
    s_nop 1
    v_add_f32_dpp v132, v134, v134 row_ror:4 row_mask:0xf bank_mask:0xf
    v_mov_b32 v134, v132
    s_nop 1
    v_add_f32_dpp v132, v134, v134 row_ror:8 row_mask:0xf bank_mask:0xf
    v_mov_b32 v134, v132
    v_mov_b32 v133, v134
    s_nop 1
    v_permlane16_swap_b32 v132, v133
    buffer_load_dwordx4 a[68:71], v9, s[24:27], s65 offen offset:1024
    v_add_f32 v134, v132, v133
    v_mul_f32 v134, 0x3acccccd, v134
    v_pk_add_f32 v[132:133], v[110:111], v[134:135] op_sel_hi:[1,0] neg_lo:[0,1] neg_hi:[0,1]
    v_pk_add_f32 v[130:131], v[112:113], v[134:135] op_sel_hi:[1,0] neg_lo:[0,1] neg_hi:[0,1]
    v_pk_mul_f32 v[136:137], v[132:133], v[132:133]
    v_pk_mul_f32 v[138:139], v[130:131], v[130:131]
    v_pk_add_f32 v[132:133], v[114:115], v[134:135] op_sel_hi:[1,0] neg_lo:[0,1] neg_hi:[0,1]
    buffer_load_dwordx4 a[72:75], v9, s[24:27], s65 offen offset:2048
    v_pk_add_f32 v[130:131], v[116:117], v[134:135] op_sel_hi:[1,0] neg_lo:[0,1] neg_hi:[0,1]
    v_pk_fma_f32 v[136:137], v[132:133], v[132:133], v[136:137]
    v_pk_fma_f32 v[138:139], v[130:131], v[130:131], v[138:139]
    v_pk_add_f32 v[132:133], v[118:119], v[134:135] op_sel_hi:[1,0] neg_lo:[0,1] neg_hi:[0,1]
    v_pk_add_f32 v[130:131], v[120:121], v[134:135] op_sel_hi:[1,0] neg_lo:[0,1] neg_hi:[0,1]
    v_pk_fma_f32 v[136:137], v[132:133], v[132:133], v[136:137]
    v_pk_fma_f32 v[138:139], v[130:131], v[130:131], v[138:139]
    buffer_load_dwordx4 a[76:79], v9, s[24:27], s65 offen offset:3072
    s_add_u32 s65, s65, 4096
    v_pk_add_f32 v[132:133], v[122:123], v[134:135] op_sel_hi:[1,0] neg_lo:[0,1] neg_hi:[0,1]
    v_pk_add_f32 v[130:131], v[124:125], v[134:135] op_sel_hi:[1,0] neg_lo:[0,1] neg_hi:[0,1]
    v_pk_fma_f32 v[136:137], v[132:133], v[132:133], v[136:137]
    v_pk_fma_f32 v[138:139], v[130:131], v[130:131], v[138:139]
    v_pk_add_f32 v[132:133], v[126:127], v[134:135] op_sel_hi:[1,0] neg_lo:[0,1] neg_hi:[0,1]
    v_pk_add_f32 v[130:131], v[128:129], v[134:135] op_sel_hi:[1,0] neg_lo:[0,1] neg_hi:[0,1]
    v_pk_fma_f32 v[136:137], v[132:133], v[132:133], v[136:137]
    buffer_load_dwordx4 a[80:83], v9, s[24:27], s65 offen offset:0
    v_pk_fma_f32 v[138:139], v[130:131], v[130:131], v[138:139]
    v_pk_add_f32 v[136:137], v[136:137], v[138:139]
    v_add_f32 v131, v136, v137
    s_nop 1
    v_add_f32_dpp v132, v131, v131 row_ror:1 row_mask:0xf bank_mask:0xf
    v_mov_b32 v131, v132
    s_nop 1
    v_add_f32_dpp v132, v131, v131 row_ror:2 row_mask:0xf bank_mask:0xf
    v_mov_b32 v131, v132
    buffer_load_dwordx4 a[84:87], v9, s[24:27], s65 offen offset:1024
    s_nop 0
    v_add_f32_dpp v132, v131, v131 row_ror:4 row_mask:0xf bank_mask:0xf
    v_mov_b32 v131, v132
    s_nop 1
    v_add_f32_dpp v132, v131, v131 row_ror:8 row_mask:0xf bank_mask:0xf
    v_mov_b32 v131, v132
    v_mov_b32 v133, v131
    s_nop 1
    v_permlane16_swap_b32 v132, v133
    v_add_f32 v131, v132, v133
    buffer_load_dwordx4 a[88:91], v9, s[24:27], s65 offen offset:2048
    v_mul_f32 v131, 0x3acccccd, v131
    v_cvt_pk_bf16_f32 v132, v134, v134
    v_lshlrev_b32 v130, 16, v132
    v_cvt_pk_bf16_f32 v133, v131, v131
    v_lshlrev_b32 v131, 16, v133
    v_add_f32 v131, 0x3727c5ac, v131
    v_cvt_pk_bf16_f32 v132, v131, v131
    buffer_load_dwordx4 a[92:95], v9, s[24:27], s65 offen offset:3072
    s_add_u32 s65, s65, 4096
    v_lshlrev_b32 v131, 16, v132
    v_sqrt_f32 v131, v131
    s_nop 0
    v_cvt_pk_bf16_f32 v132, v131, v131
    v_lshlrev_b32 v131, 16, v132
    v_rcp_f32 v131, v131
    s_lshr_b32 s62, s60, 1
    s_mul_i32 s62, s62, 20480
    s_and_b32 s63, s60, 1
    s_lshl_b32 s63, s63, 7
    s_add_u32 s62, s62, s63
    s_add_u32 s62, s62, s53
    v_pk_add_f32 v[140:141], v[110:111], v[130:131] op_sel_hi:[1,0] neg_lo:[0,1] neg_hi:[0,1]
    v_pk_add_f32 v[144:145], v[112:113], v[130:131] op_sel_hi:[1,0] neg_lo:[0,1] neg_hi:[0,1]
    v_pk_add_f32 v[148:149], v[114:115], v[130:131] op_sel_hi:[1,0] neg_lo:[0,1] neg_hi:[0,1]
    v_pk_add_f32 v[152:153], v[116:117], v[130:131] op_sel_hi:[1,0] neg_lo:[0,1] neg_hi:[0,1]
    v_pk_add_f32 v[156:157], v[118:119], v[130:131] op_sel_hi:[1,0] neg_lo:[0,1] neg_hi:[0,1]
    v_cvt_pk_bf16_f32 v142, v140, v141
    v_cvt_pk_bf16_f32 v146, v144, v145
    v_cvt_pk_bf16_f32 v150, v148, v149
    v_cvt_pk_bf16_f32 v154, v152, v153
    v_cvt_pk_bf16_f32 v158, v156, v157
    v_lshlrev_b32 v140, 16, v142
    v_lshlrev_b32 v144, 16, v146
    v_lshlrev_b32 v148, 16, v150
    v_lshlrev_b32 v152, 16, v154
    v_lshlrev_b32 v156, 16, v158
    v_and_b32 v141, 0xffff0000, v142
    v_and_b32 v145, 0xffff0000, v146
    v_and_b32 v149, 0xffff0000, v150
    v_and_b32 v153, 0xffff0000, v154
    v_and_b32 v157, 0xffff0000, v158
    v_pk_mul_f32 v[140:141], v[140:141], v[130:131] op_sel:[0,1] op_sel_hi:[1,1]
    v_pk_mul_f32 v[144:145], v[144:145], v[130:131] op_sel:[0,1] op_sel_hi:[1,1]
    v_pk_mul_f32 v[148:149], v[148:149], v[130:131] op_sel:[0,1] op_sel_hi:[1,1]
    v_pk_mul_f32 v[152:153], v[152:153], v[130:131] op_sel:[0,1] op_sel_hi:[1,1]
    v_pk_mul_f32 v[156:157], v[156:157], v[130:131] op_sel:[0,1] op_sel_hi:[1,1]
    v_cvt_pk_bf16_f32 v76, v140, v141
    v_cvt_pk_bf16_f32 v77, v144, v145
    v_cvt_pk_bf16_f32 v78, v148, v149
    v_cvt_pk_bf16_f32 v79, v152, v153
    v_cvt_pk_bf16_f32 v80, v156, v157
    v_pk_add_f32 v[140:141], v[120:121], v[130:131] op_sel_hi:[1,0] neg_lo:[0,1] neg_hi:[0,1]
    v_pk_add_f32 v[144:145], v[122:123], v[130:131] op_sel_hi:[1,0] neg_lo:[0,1] neg_hi:[0,1]
    v_pk_add_f32 v[148:149], v[124:125], v[130:131] op_sel_hi:[1,0] neg_lo:[0,1] neg_hi:[0,1]
    v_pk_add_f32 v[152:153], v[126:127], v[130:131] op_sel_hi:[1,0] neg_lo:[0,1] neg_hi:[0,1]
    v_pk_add_f32 v[156:157], v[128:129], v[130:131] op_sel_hi:[1,0] neg_lo:[0,1] neg_hi:[0,1]
    v_cvt_pk_bf16_f32 v142, v140, v141
    v_cvt_pk_bf16_f32 v146, v144, v145
    v_cvt_pk_bf16_f32 v150, v148, v149
    v_cvt_pk_bf16_f32 v154, v152, v153
    v_cvt_pk_bf16_f32 v158, v156, v157
    v_lshlrev_b32 v140, 16, v142
    v_lshlrev_b32 v144, 16, v146
    v_lshlrev_b32 v148, 16, v150
    v_lshlrev_b32 v152, 16, v154
    v_lshlrev_b32 v156, 16, v158
    v_and_b32 v141, 0xffff0000, v142
    v_and_b32 v145, 0xffff0000, v146
    v_and_b32 v149, 0xffff0000, v150
    v_and_b32 v153, 0xffff0000, v154
    v_and_b32 v157, 0xffff0000, v158
    v_pk_mul_f32 v[140:141], v[140:141], v[130:131] op_sel:[0,1] op_sel_hi:[1,1]
    v_pk_mul_f32 v[144:145], v[144:145], v[130:131] op_sel:[0,1] op_sel_hi:[1,1]
    v_pk_mul_f32 v[148:149], v[148:149], v[130:131] op_sel:[0,1] op_sel_hi:[1,1]
    v_pk_mul_f32 v[152:153], v[152:153], v[130:131] op_sel:[0,1] op_sel_hi:[1,1]
    v_pk_mul_f32 v[156:157], v[156:157], v[130:131] op_sel:[0,1] op_sel_hi:[1,1]
    v_cvt_pk_bf16_f32 v81, v140, v141
    v_cvt_pk_bf16_f32 v82, v144, v145
    v_cvt_pk_bf16_f32 v83, v148, v149
    v_cvt_pk_bf16_f32 v84, v152, v153
    v_cvt_pk_bf16_f32 v85, v156, v157
    s_cmp_eq_u32 s19, 0
    s_cbranch_scc1 D_slow4
    buffer_store_dwordx2 v[76:77], v8, s[24:27], s62 offen
    s_add_u32 s62, s62, 4096
    buffer_store_dwordx2 v[78:79], v8, s[24:27], s62 offen
    s_add_u32 s62, s62, 4096
    buffer_store_dwordx2 v[80:81], v8, s[24:27], s62 offen
    s_add_u32 s62, s62, 4096
    buffer_store_dwordx2 v[82:83], v8, s[24:27], s62 offen
    s_add_u32 s62, s62, 4096
    buffer_store_dwordx2 v[84:85], v8, s[24:27], s62 offen
    s_add_u32 s62, s62, 4096
    s_branch D_end4
D_slow4:
    buffer_store_dwordx2 v[76:77], v8, s[24:27], s62 offen sc1
    s_add_u32 s62, s62, 4096
    buffer_store_dwordx2 v[78:79], v8, s[24:27], s62 offen sc1
    s_add_u32 s62, s62, 4096
    buffer_store_dwordx2 v[80:81], v8, s[24:27], s62 offen sc1
    s_add_u32 s62, s62, 4096
    buffer_store_dwordx2 v[82:83], v8, s[24:27], s62 offen sc1
    s_add_u32 s62, s62, 4096
    buffer_store_dwordx2 v[84:85], v8, s[24:27], s62 offen sc1
    s_add_u32 s62, s62, 4096
D_end4:
    s_waitcnt vmcnt(0)
    s_branch F_l_done
F_l1:
    s_nop 7
    s_nop 7
    s_waitcnt vmcnt(0)
    ds_write_b32 v6, v76 offset:0
    ds_write_b32 v6, v80 offset:4352
    ds_write_b32 v6, v77 offset:4
    ds_write_b32 v6, v81 offset:4356
    ds_write_b32 v6, v78 offset:8
    ds_write_b32 v6, v82 offset:4360
    ds_write_b32 v6, v79 offset:12
    ds_write_b32 v6, v83 offset:4364
    s_cmp_ge_u32 s50, 2
    s_cbranch_scc1 F_skipwb
    ds_write_b32 v6, v84 offset:8704
    ds_write_b32 v6, v85 offset:8708
    ds_write_b32 v6, v86 offset:8712
    ds_write_b32 v6, v87 offset:8716
F_skipwb:
    v_mov_b32 v90, 0
    v_mov_b32 v91, 0
    v_mov_b32 v92, 0
    v_mov_b32 v93, 0
    v_mov_b32 v94, 0
    v_mov_b32 v95, 0
    v_mov_b32 v96, 0
    v_mov_b32 v97, 0
    v_mov_b32 v98, 0
    v_mov_b32 v99, 0
    v_mov_b32 v100, 0
    v_mov_b32 v101, 0
    v_mov_b32 v102, 0
    v_mov_b32 v103, 0
    v_mov_b32 v104, 0
    v_mov_b32 v105, 0
    v_mov_b32 v106, 0
    v_mov_b32 v107, 0
    v_mov_b32 v108, 0
    v_mov_b32 v109, 0
    v_lshlrev_b32 v110, 16, v64
    v_and_b32 v111, 0xffff0000, v64
    v_lshlrev_b32 v112, 16, v65
    v_and_b32 v113, 0xffff0000, v65
    v_lshlrev_b32 v114, 16, v66
    v_and_b32 v115, 0xffff0000, v66
    v_lshlrev_b32 v116, 16, v67
    v_and_b32 v117, 0xffff0000, v67
    v_lshlrev_b32 v118, 16, v68
    v_and_b32 v119, 0xffff0000, v68
    v_lshlrev_b32 v120, 16, v69
    v_and_b32 v121, 0xffff0000, v69
    v_lshlrev_b32 v122, 16, v70
    v_and_b32 v123, 0xffff0000, v70
    v_lshlrev_b32 v124, 16, v71
    v_and_b32 v125, 0xffff0000, v71
    v_lshlrev_b32 v126, 16, v72
    v_and_b32 v127, 0xffff0000, v72
    v_lshlrev_b32 v128, 16, v73
    v_and_b32 v129, 0xffff0000, v73
    s_waitcnt lgkmcnt(0)
    s_barrier
    ds_read_u16_d16_hi v90, v7 offset:0
    ds_read_u16_d16_hi v91, v7 offset:16
    ds_read_u16_d16_hi v92, v7 offset:32
    ds_read_u16_d16_hi v93, v7 offset:48
    ds_read_u16_d16_hi v94, v7 offset:2176
    ds_read_u16_d16_hi v95, v7 offset:2192
    ds_read_u16_d16_hi v96, v7 offset:2208
    ds_read_u16_d16_hi v97, v7 offset:2224
    ds_read_u16_d16_hi v98, v7 offset:4352
    ds_read_u16_d16_hi v99, v7 offset:4368
    ds_read_u16_d16_hi v100, v7 offset:4384
    ds_read_u16_d16_hi v101, v7 offset:4400
    ds_read_u16_d16_hi v102, v7 offset:6528
    ds_read_u16_d16_hi v103, v7 offset:6544
    ds_read_u16_d16_hi v104, v7 offset:6560
    ds_read_u16_d16_hi v105, v7 offset:6576
    ds_read_u16_d16_hi v106, v7 offset:8704
    ds_read_u16_d16_hi v107, v7 offset:8720
    ds_read_u16_d16_hi v108, v7 offset:8736
    ds_read_u16_d16_hi v109, v7 offset:8752
    v_pk_add_f32 v[134:135], v[110:111], v[112:113]
    v_pk_add_f32 v[136:137], v[114:115], v[116:117]
    v_pk_add_f32 v[134:135], v[134:135], v[118:119]
    v_pk_add_f32 v[136:137], v[136:137], v[120:121]
    v_pk_add_f32 v[134:135], v[134:135], v[122:123]
    v_pk_add_f32 v[136:137], v[136:137], v[124:125]
    v_pk_add_f32 v[134:135], v[134:135], v[126:127]
    v_pk_add_f32 v[136:137], v[136:137], v[128:129]
    v_pk_add_f32 v[134:135], v[134:135], v[136:137]
    v_add_f32 v134, v134, v135
    s_nop 1
    v_add_f32_dpp v132, v134, v134 row_ror:1 row_mask:0xf bank_mask:0xf
    v_mov_b32 v134, v132
    s_nop 1
    v_add_f32_dpp v132, v134, v134 row_ror:2 row_mask:0xf bank_mask:0xf
    v_mov_b32 v134, v132
    s_nop 1
    v_add_f32_dpp v132, v134, v134 row_ror:4 row_mask:0xf bank_mask:0xf
    v_mov_b32 v134, v132
    s_nop 1
    v_add_f32_dpp v132, v134, v134 row_ror:8 row_mask:0xf bank_mask:0xf
    v_mov_b32 v134, v132
    v_mov_b32 v133, v134
    s_nop 1
    v_permlane16_swap_b32 v132, v133
    v_add_f32 v134, v132, v133
    v_mul_f32 v134, 0x3acccccd, v134
    v_pk_add_f32 v[132:133], v[110:111], v[134:135] op_sel_hi:[1,0] neg_lo:[0,1] neg_hi:[0,1]
    v_pk_add_f32 v[130:131], v[112:113], v[134:135] op_sel_hi:[1,0] neg_lo:[0,1] neg_hi:[0,1]
    v_pk_mul_f32 v[136:137], v[132:133], v[132:133]
    v_pk_mul_f32 v[138:139], v[130:131], v[130:131]
    v_pk_add_f32 v[132:133], v[114:115], v[134:135] op_sel_hi:[1,0] neg_lo:[0,1] neg_hi:[0,1]
    v_pk_add_f32 v[130:131], v[116:117], v[134:135] op_sel_hi:[1,0] neg_lo:[0,1] neg_hi:[0,1]
    v_pk_fma_f32 v[136:137], v[132:133], v[132:133], v[136:137]
    v_pk_fma_f32 v[138:139], v[130:131], v[130:131], v[138:139]
    v_pk_add_f32 v[132:133], v[118:119], v[134:135] op_sel_hi:[1,0] neg_lo:[0,1] neg_hi:[0,1]
    v_pk_add_f32 v[130:131], v[120:121], v[134:135] op_sel_hi:[1,0] neg_lo:[0,1] neg_hi:[0,1]
    v_pk_fma_f32 v[136:137], v[132:133], v[132:133], v[136:137]
    v_pk_fma_f32 v[138:139], v[130:131], v[130:131], v[138:139]
    v_pk_add_f32 v[132:133], v[122:123], v[134:135] op_sel_hi:[1,0] neg_lo:[0,1] neg_hi:[0,1]
    v_pk_add_f32 v[130:131], v[124:125], v[134:135] op_sel_hi:[1,0] neg_lo:[0,1] neg_hi:[0,1]
    v_pk_fma_f32 v[136:137], v[132:133], v[132:133], v[136:137]
    v_pk_fma_f32 v[138:139], v[130:131], v[130:131], v[138:139]
    v_pk_add_f32 v[132:133], v[126:127], v[134:135] op_sel_hi:[1,0] neg_lo:[0,1] neg_hi:[0,1]
    v_pk_add_f32 v[130:131], v[128:129], v[134:135] op_sel_hi:[1,0] neg_lo:[0,1] neg_hi:[0,1]
    v_pk_fma_f32 v[136:137], v[132:133], v[132:133], v[136:137]
    v_pk_fma_f32 v[138:139], v[130:131], v[130:131], v[138:139]
    v_pk_add_f32 v[136:137], v[136:137], v[138:139]
    v_add_f32 v131, v136, v137
    s_nop 1
    v_add_f32_dpp v132, v131, v131 row_ror:1 row_mask:0xf bank_mask:0xf
    v_mov_b32 v131, v132
    s_nop 1
    v_add_f32_dpp v132, v131, v131 row_ror:2 row_mask:0xf bank_mask:0xf
    v_mov_b32 v131, v132
    s_nop 1
    v_add_f32_dpp v132, v131, v131 row_ror:4 row_mask:0xf bank_mask:0xf
    v_mov_b32 v131, v132
    s_nop 1
    v_add_f32_dpp v132, v131, v131 row_ror:8 row_mask:0xf bank_mask:0xf
    v_mov_b32 v131, v132
    v_mov_b32 v133, v131
    s_nop 1
    v_permlane16_swap_b32 v132, v133
    v_add_f32 v131, v132, v133
    v_mul_f32 v131, 0x3acccccd, v131
    v_cvt_pk_bf16_f32 v132, v134, v134
    v_lshlrev_b32 v130, 16, v132
    v_cvt_pk_bf16_f32 v133, v131, v131
    v_lshlrev_b32 v131, 16, v133
    v_add_f32 v131, 0x3727c5ac, v131
    v_cvt_pk_bf16_f32 v132, v131, v131
    v_lshlrev_b32 v131, 16, v132
    v_sqrt_f32 v131, v131
    s_nop 0
    v_cvt_pk_bf16_f32 v132, v131, v131
    v_lshlrev_b32 v131, 16, v132
    v_rcp_f32 v131, v131
    s_waitcnt lgkmcnt(0)
    v_pk_add_f32 v[140:141], v[110:111], v[130:131] op_sel_hi:[1,0] neg_lo:[0,1] neg_hi:[0,1]
    v_pk_add_f32 v[144:145], v[112:113], v[130:131] op_sel_hi:[1,0] neg_lo:[0,1] neg_hi:[0,1]
    v_pk_add_f32 v[148:149], v[114:115], v[130:131] op_sel_hi:[1,0] neg_lo:[0,1] neg_hi:[0,1]
    v_pk_add_f32 v[152:153], v[116:117], v[130:131] op_sel_hi:[1,0] neg_lo:[0,1] neg_hi:[0,1]
    v_pk_add_f32 v[156:157], v[118:119], v[130:131] op_sel_hi:[1,0] neg_lo:[0,1] neg_hi:[0,1]
    v_cvt_pk_bf16_f32 v142, v140, v141
    v_cvt_pk_bf16_f32 v146, v144, v145
    v_cvt_pk_bf16_f32 v150, v148, v149
    v_cvt_pk_bf16_f32 v154, v152, v153
    v_cvt_pk_bf16_f32 v158, v156, v157
    v_lshlrev_b32 v140, 16, v142
    v_lshlrev_b32 v144, 16, v146
    v_lshlrev_b32 v148, 16, v150
    v_lshlrev_b32 v152, 16, v154
    v_lshlrev_b32 v156, 16, v158
    v_and_b32 v141, 0xffff0000, v142
    v_and_b32 v145, 0xffff0000, v146
    v_and_b32 v149, 0xffff0000, v150
    v_and_b32 v153, 0xffff0000, v154
    v_and_b32 v157, 0xffff0000, v158
    v_pk_mul_f32 v[140:141], v[140:141], v[130:131] op_sel:[0,1] op_sel_hi:[1,1]
    v_pk_mul_f32 v[144:145], v[144:145], v[130:131] op_sel:[0,1] op_sel_hi:[1,1]
    v_pk_mul_f32 v[148:149], v[148:149], v[130:131] op_sel:[0,1] op_sel_hi:[1,1]
    v_pk_mul_f32 v[152:153], v[152:153], v[130:131] op_sel:[0,1] op_sel_hi:[1,1]
    v_pk_mul_f32 v[156:157], v[156:157], v[130:131] op_sel:[0,1] op_sel_hi:[1,1]
    v_cvt_pk_bf16_f32 v142, v140, v141
    v_cvt_pk_bf16_f32 v146, v144, v145
    v_cvt_pk_bf16_f32 v150, v148, v149
    v_cvt_pk_bf16_f32 v154, v152, v153
    v_cvt_pk_bf16_f32 v158, v156, v157
    v_lshlrev_b32 v140, 16, v142
    v_lshlrev_b32 v144, 16, v146
    v_lshlrev_b32 v148, 16, v150
    v_lshlrev_b32 v152, 16, v154
    v_lshlrev_b32 v156, 16, v158
    v_and_b32 v141, 0xffff0000, v142
    v_and_b32 v145, 0xffff0000, v146
    v_and_b32 v149, 0xffff0000, v150
    v_and_b32 v153, 0xffff0000, v154
    v_and_b32 v157, 0xffff0000, v158
    v_pk_mul_f32 v[140:141], v[140:141], v[90:91]
    v_pk_mul_f32 v[144:145], v[144:145], v[92:93]
    v_pk_mul_f32 v[148:149], v[148:149], v[94:95]
    v_pk_mul_f32 v[152:153], v[152:153], v[96:97]
    v_pk_mul_f32 v[156:157], v[156:157], v[98:99]
    v_cvt_pk_bf16_f32 v142, v140, v141
    v_cvt_pk_bf16_f32 v146, v144, v145
    v_cvt_pk_bf16_f32 v150, v148, v149
    v_cvt_pk_bf16_f32 v154, v152, v153
    v_cvt_pk_bf16_f32 v158, v156, v157
    v_lshlrev_b32 v140, 16, v142
    v_lshlrev_b32 v144, 16, v146
    v_lshlrev_b32 v148, 16, v150
    v_lshlrev_b32 v152, 16, v154
    v_lshlrev_b32 v156, 16, v158
    v_and_b32 v141, 0xffff0000, v142
    v_and_b32 v145, 0xffff0000, v146
    v_and_b32 v149, 0xffff0000, v150
    v_and_b32 v153, 0xffff0000, v154
    v_and_b32 v157, 0xffff0000, v158
    v_pk_add_f32 v[140:141], v[110:111], v[140:141]
    v_pk_add_f32 v[144:145], v[112:113], v[144:145]
    v_pk_add_f32 v[148:149], v[114:115], v[148:149]
    v_pk_add_f32 v[152:153], v[116:117], v[152:153]
    v_pk_add_f32 v[156:157], v[118:119], v[156:157]
    v_cvt_pk_bf16_f32 v64, v140, v141
    v_cvt_pk_bf16_f32 v65, v144, v145
    v_cvt_pk_bf16_f32 v66, v148, v149
    v_cvt_pk_bf16_f32 v67, v152, v153
    v_cvt_pk_bf16_f32 v68, v156, v157
    v_lshlrev_b32 v110, 16, v64
    v_lshlrev_b32 v112, 16, v65
    v_lshlrev_b32 v114, 16, v66
    v_lshlrev_b32 v116, 16, v67
    v_lshlrev_b32 v118, 16, v68
    v_and_b32 v111, 0xffff0000, v64
    v_and_b32 v113, 0xffff0000, v65
    v_and_b32 v115, 0xffff0000, v66
    v_and_b32 v117, 0xffff0000, v67
    v_and_b32 v119, 0xffff0000, v68
    v_pk_add_f32 v[140:141], v[120:121], v[130:131] op_sel_hi:[1,0] neg_lo:[0,1] neg_hi:[0,1]
    v_pk_add_f32 v[144:145], v[122:123], v[130:131] op_sel_hi:[1,0] neg_lo:[0,1] neg_hi:[0,1]
    v_pk_add_f32 v[148:149], v[124:125], v[130:131] op_sel_hi:[1,0] neg_lo:[0,1] neg_hi:[0,1]
    v_pk_add_f32 v[152:153], v[126:127], v[130:131] op_sel_hi:[1,0] neg_lo:[0,1] neg_hi:[0,1]
    v_pk_add_f32 v[156:157], v[128:129], v[130:131] op_sel_hi:[1,0] neg_lo:[0,1] neg_hi:[0,1]
    v_cvt_pk_bf16_f32 v142, v140, v141
    v_cvt_pk_bf16_f32 v146, v144, v145
    v_cvt_pk_bf16_f32 v150, v148, v149
    v_cvt_pk_bf16_f32 v154, v152, v153
    v_cvt_pk_bf16_f32 v158, v156, v157
    v_lshlrev_b32 v140, 16, v142
    v_lshlrev_b32 v144, 16, v146
    v_lshlrev_b32 v148, 16, v150
    v_lshlrev_b32 v152, 16, v154
    v_lshlrev_b32 v156, 16, v158
    v_and_b32 v141, 0xffff0000, v142
    v_and_b32 v145, 0xffff0000, v146
    v_and_b32 v149, 0xffff0000, v150
    v_and_b32 v153, 0xffff0000, v154
    v_and_b32 v157, 0xffff0000, v158
    v_pk_mul_f32 v[140:141], v[140:141], v[130:131] op_sel:[0,1] op_sel_hi:[1,1]
    v_pk_mul_f32 v[144:145], v[144:145], v[130:131] op_sel:[0,1] op_sel_hi:[1,1]
    v_pk_mul_f32 v[148:149], v[148:149], v[130:131] op_sel:[0,1] op_sel_hi:[1,1]
    v_pk_mul_f32 v[152:153], v[152:153], v[130:131] op_sel:[0,1] op_sel_hi:[1,1]
    v_pk_mul_f32 v[156:157], v[156:157], v[130:131] op_sel:[0,1] op_sel_hi:[1,1]
    v_cvt_pk_bf16_f32 v142, v140, v141
    v_cvt_pk_bf16_f32 v146, v144, v145
    v_cvt_pk_bf16_f32 v150, v148, v149
    v_cvt_pk_bf16_f32 v154, v152, v153
    v_cvt_pk_bf16_f32 v158, v156, v157
    v_lshlrev_b32 v140, 16, v142
    v_lshlrev_b32 v144, 16, v146
    v_lshlrev_b32 v148, 16, v150
    v_lshlrev_b32 v152, 16, v154
    v_lshlrev_b32 v156, 16, v158
    v_and_b32 v141, 0xffff0000, v142
    v_and_b32 v145, 0xffff0000, v146
    v_and_b32 v149, 0xffff0000, v150
    v_and_b32 v153, 0xffff0000, v154
    v_and_b32 v157, 0xffff0000, v158
    v_pk_mul_f32 v[140:141], v[140:141], v[100:101]
    v_pk_mul_f32 v[144:145], v[144:145], v[102:103]
    v_pk_mul_f32 v[148:149], v[148:149], v[104:105]
    v_pk_mul_f32 v[152:153], v[152:153], v[106:107]
    v_pk_mul_f32 v[156:157], v[156:157], v[108:109]
    v_cvt_pk_bf16_f32 v142, v140, v141
    v_cvt_pk_bf16_f32 v146, v144, v145
    v_cvt_pk_bf16_f32 v150, v148, v149
    v_cvt_pk_bf16_f32 v154, v152, v153
    v_cvt_pk_bf16_f32 v158, v156, v157
    v_lshlrev_b32 v140, 16, v142
    v_lshlrev_b32 v144, 16, v146
    v_lshlrev_b32 v148, 16, v150
    v_lshlrev_b32 v152, 16, v154
    v_lshlrev_b32 v156, 16, v158
    v_and_b32 v141, 0xffff0000, v142
    v_and_b32 v145, 0xffff0000, v146
    v_and_b32 v149, 0xffff0000, v150
    v_and_b32 v153, 0xffff0000, v154
    v_and_b32 v157, 0xffff0000, v158
    v_pk_add_f32 v[140:141], v[120:121], v[140:141]
    v_pk_add_f32 v[144:145], v[122:123], v[144:145]
    v_pk_add_f32 v[148:149], v[124:125], v[148:149]
    v_pk_add_f32 v[152:153], v[126:127], v[152:153]
    v_pk_add_f32 v[156:157], v[128:129], v[156:157]
    v_cvt_pk_bf16_f32 v69, v140, v141
    v_cvt_pk_bf16_f32 v70, v144, v145
    v_cvt_pk_bf16_f32 v71, v148, v149
    v_cvt_pk_bf16_f32 v72, v152, v153
    v_cvt_pk_bf16_f32 v73, v156, v157
    v_lshlrev_b32 v120, 16, v69
    v_lshlrev_b32 v122, 16, v70
    v_lshlrev_b32 v124, 16, v71
    v_lshlrev_b32 v126, 16, v72
    v_lshlrev_b32 v128, 16, v73
    v_and_b32 v121, 0xffff0000, v69
    v_and_b32 v123, 0xffff0000, v70
    v_and_b32 v125, 0xffff0000, v71
    v_and_b32 v127, 0xffff0000, v72
    v_and_b32 v129, 0xffff0000, v73
    s_add_u32 s62, s61, s52
    s_cmp_eq_u32 s19, 0
    s_cbranch_scc1 D_slow5
    buffer_store_dwordx2 v[64:65], v1, s[24:27], s62 offen offset:0
    buffer_store_dwordx2 v[66:67], v1, s[24:27], s62 offen offset:256
    buffer_store_dwordx2 v[68:69], v1, s[24:27], s62 offen offset:512
    buffer_store_dwordx2 v[70:71], v1, s[24:27], s62 offen offset:768
    buffer_store_dwordx2 v[72:73], v1, s[24:27], s62 offen offset:1024
    s_branch D_end5
D_slow5:
    buffer_store_dwordx2 v[64:65], v1, s[24:27], s62 offen offset:0 sc1
    buffer_store_dwordx2 v[66:67], v1, s[24:27], s62 offen offset:256 sc1
    buffer_store_dwordx2 v[68:69], v1, s[24:27], s62 offen offset:512 sc1
    buffer_store_dwordx2 v[70:71], v1, s[24:27], s62 offen offset:768 sc1
    buffer_store_dwordx2 v[72:73], v1, s[24:27], s62 offen offset:1024 sc1
D_end5:
    v_pk_add_f32 v[134:135], v[110:111], v[112:113]
    v_pk_add_f32 v[136:137], v[114:115], v[116:117]
    v_pk_add_f32 v[134:135], v[134:135], v[118:119]
    v_pk_add_f32 v[136:137], v[136:137], v[120:121]
    v_pk_add_f32 v[134:135], v[134:135], v[122:123]
    v_pk_add_f32 v[136:137], v[136:137], v[124:125]
    v_pk_add_f32 v[134:135], v[134:135], v[126:127]
    v_pk_add_f32 v[136:137], v[136:137], v[128:129]
    v_pk_add_f32 v[134:135], v[134:135], v[136:137]
    v_add_f32 v134, v134, v135
    s_nop 1
    v_add_f32_dpp v132, v134, v134 row_ror:1 row_mask:0xf bank_mask:0xf
    v_mov_b32 v134, v132
    s_nop 1
    v_add_f32_dpp v132, v134, v134 row_ror:2 row_mask:0xf bank_mask:0xf
    v_mov_b32 v134, v132
    s_nop 1
    v_add_f32_dpp v132, v134, v134 row_ror:4 row_mask:0xf bank_mask:0xf
    v_mov_b32 v134, v132
    s_nop 1
    v_add_f32_dpp v132, v134, v134 row_ror:8 row_mask:0xf bank_mask:0xf
    v_mov_b32 v134, v132
    v_mov_b32 v133, v134
    s_nop 1
    v_permlane16_swap_b32 v132, v133
    v_add_f32 v134, v132, v133
    v_mul_f32 v134, 0x3acccccd, v134
    v_pk_add_f32 v[132:133], v[110:111], v[134:135] op_sel_hi:[1,0] neg_lo:[0,1] neg_hi:[0,1]
    v_pk_add_f32 v[130:131], v[112:113], v[134:135] op_sel_hi:[1,0] neg_lo:[0,1] neg_hi:[0,1]
    v_pk_mul_f32 v[136:137], v[132:133], v[132:133]
    v_pk_mul_f32 v[138:139], v[130:131], v[130:131]
    v_pk_add_f32 v[132:133], v[114:115], v[134:135] op_sel_hi:[1,0] neg_lo:[0,1] neg_hi:[0,1]
    v_pk_add_f32 v[130:131], v[116:117], v[134:135] op_sel_hi:[1,0] neg_lo:[0,1] neg_hi:[0,1]
    v_pk_fma_f32 v[136:137], v[132:133], v[132:133], v[136:137]
    v_pk_fma_f32 v[138:139], v[130:131], v[130:131], v[138:139]
    v_pk_add_f32 v[132:133], v[118:119], v[134:135] op_sel_hi:[1,0] neg_lo:[0,1] neg_hi:[0,1]
    v_pk_add_f32 v[130:131], v[120:121], v[134:135] op_sel_hi:[1,0] neg_lo:[0,1] neg_hi:[0,1]
    v_pk_fma_f32 v[136:137], v[132:133], v[132:133], v[136:137]
    v_pk_fma_f32 v[138:139], v[130:131], v[130:131], v[138:139]
    v_pk_add_f32 v[132:133], v[122:123], v[134:135] op_sel_hi:[1,0] neg_lo:[0,1] neg_hi:[0,1]
    v_pk_add_f32 v[130:131], v[124:125], v[134:135] op_sel_hi:[1,0] neg_lo:[0,1] neg_hi:[0,1]
    v_pk_fma_f32 v[136:137], v[132:133], v[132:133], v[136:137]
    v_pk_fma_f32 v[138:139], v[130:131], v[130:131], v[138:139]
    v_pk_add_f32 v[132:133], v[126:127], v[134:135] op_sel_hi:[1,0] neg_lo:[0,1] neg_hi:[0,1]
    v_pk_add_f32 v[130:131], v[128:129], v[134:135] op_sel_hi:[1,0] neg_lo:[0,1] neg_hi:[0,1]
    v_pk_fma_f32 v[136:137], v[132:133], v[132:133], v[136:137]
    v_pk_fma_f32 v[138:139], v[130:131], v[130:131], v[138:139]
    v_pk_add_f32 v[136:137], v[136:137], v[138:139]
    v_add_f32 v131, v136, v137
    s_nop 1
    v_add_f32_dpp v132, v131, v131 row_ror:1 row_mask:0xf bank_mask:0xf
    v_mov_b32 v131, v132
    s_nop 1
    v_add_f32_dpp v132, v131, v131 row_ror:2 row_mask:0xf bank_mask:0xf
    v_mov_b32 v131, v132
    s_nop 1
    v_add_f32_dpp v132, v131, v131 row_ror:4 row_mask:0xf bank_mask:0xf
    v_mov_b32 v131, v132
    s_nop 1
    v_add_f32_dpp v132, v131, v131 row_ror:8 row_mask:0xf bank_mask:0xf
    v_mov_b32 v131, v132
    v_mov_b32 v133, v131
    s_nop 1
    v_permlane16_swap_b32 v132, v133
    v_add_f32 v131, v132, v133
    v_mul_f32 v131, 0x3acccccd, v131
    v_cvt_pk_bf16_f32 v132, v134, v134
    v_lshlrev_b32 v130, 16, v132
    v_cvt_pk_bf16_f32 v133, v131, v131
    v_lshlrev_b32 v131, 16, v133
    v_add_f32 v131, 0x3727c5ac, v131
    v_cvt_pk_bf16_f32 v132, v131, v131
    v_lshlrev_b32 v131, 16, v132
    v_sqrt_f32 v131, v131
    s_nop 0
    v_cvt_pk_bf16_f32 v132, v131, v131
    v_lshlrev_b32 v131, 16, v132
    v_rcp_f32 v131, v131
    s_lshr_b32 s62, s60, 1
    s_mul_i32 s62, s62, 20480
    s_and_b32 s63, s60, 1
    s_lshl_b32 s63, s63, 7
    s_add_u32 s62, s62, s63
    s_add_u32 s62, s62, s53
    v_pk_add_f32 v[140:141], v[110:111], v[130:131] op_sel_hi:[1,0] neg_lo:[0,1] neg_hi:[0,1]
    v_pk_add_f32 v[144:145], v[112:113], v[130:131] op_sel_hi:[1,0] neg_lo:[0,1] neg_hi:[0,1]
    v_pk_add_f32 v[148:149], v[114:115], v[130:131] op_sel_hi:[1,0] neg_lo:[0,1] neg_hi:[0,1]
    v_pk_add_f32 v[152:153], v[116:117], v[130:131] op_sel_hi:[1,0] neg_lo:[0,1] neg_hi:[0,1]
    v_pk_add_f32 v[156:157], v[118:119], v[130:131] op_sel_hi:[1,0] neg_lo:[0,1] neg_hi:[0,1]
    v_cvt_pk_bf16_f32 v142, v140, v141
    v_cvt_pk_bf16_f32 v146, v144, v145
    v_cvt_pk_bf16_f32 v150, v148, v149
    v_cvt_pk_bf16_f32 v154, v152, v153
    v_cvt_pk_bf16_f32 v158, v156, v157
    v_lshlrev_b32 v140, 16, v142
    v_lshlrev_b32 v144, 16, v146
    v_lshlrev_b32 v148, 16, v150
    v_lshlrev_b32 v152, 16, v154
    v_lshlrev_b32 v156, 16, v158
    v_and_b32 v141, 0xffff0000, v142
    v_and_b32 v145, 0xffff0000, v146
    v_and_b32 v149, 0xffff0000, v150
    v_and_b32 v153, 0xffff0000, v154
    v_and_b32 v157, 0xffff0000, v158
    v_pk_mul_f32 v[140:141], v[140:141], v[130:131] op_sel:[0,1] op_sel_hi:[1,1]
    v_pk_mul_f32 v[144:145], v[144:145], v[130:131] op_sel:[0,1] op_sel_hi:[1,1]
    v_pk_mul_f32 v[148:149], v[148:149], v[130:131] op_sel:[0,1] op_sel_hi:[1,1]
    v_pk_mul_f32 v[152:153], v[152:153], v[130:131] op_sel:[0,1] op_sel_hi:[1,1]
    v_pk_mul_f32 v[156:157], v[156:157], v[130:131] op_sel:[0,1] op_sel_hi:[1,1]
    v_cvt_pk_bf16_f32 v76, v140, v141
    v_cvt_pk_bf16_f32 v77, v144, v145
    v_cvt_pk_bf16_f32 v78, v148, v149
    v_cvt_pk_bf16_f32 v79, v152, v153
    v_cvt_pk_bf16_f32 v80, v156, v157
    v_pk_add_f32 v[140:141], v[120:121], v[130:131] op_sel_hi:[1,0] neg_lo:[0,1] neg_hi:[0,1]
    v_pk_add_f32 v[144:145], v[122:123], v[130:131] op_sel_hi:[1,0] neg_lo:[0,1] neg_hi:[0,1]
    v_pk_add_f32 v[148:149], v[124:125], v[130:131] op_sel_hi:[1,0] neg_lo:[0,1] neg_hi:[0,1]
    v_pk_add_f32 v[152:153], v[126:127], v[130:131] op_sel_hi:[1,0] neg_lo:[0,1] neg_hi:[0,1]
    v_pk_add_f32 v[156:157], v[128:129], v[130:131] op_sel_hi:[1,0] neg_lo:[0,1] neg_hi:[0,1]
    v_cvt_pk_bf16_f32 v142, v140, v141
    v_cvt_pk_bf16_f32 v146, v144, v145
    v_cvt_pk_bf16_f32 v150, v148, v149
    v_cvt_pk_bf16_f32 v154, v152, v153
    v_cvt_pk_bf16_f32 v158, v156, v157
    v_lshlrev_b32 v140, 16, v142
    v_lshlrev_b32 v144, 16, v146
    v_lshlrev_b32 v148, 16, v150
    v_lshlrev_b32 v152, 16, v154
    v_lshlrev_b32 v156, 16, v158
    v_and_b32 v141, 0xffff0000, v142
    v_and_b32 v145, 0xffff0000, v146
    v_and_b32 v149, 0xffff0000, v150
    v_and_b32 v153, 0xffff0000, v154
    v_and_b32 v157, 0xffff0000, v158
    v_pk_mul_f32 v[140:141], v[140:141], v[130:131] op_sel:[0,1] op_sel_hi:[1,1]
    v_pk_mul_f32 v[144:145], v[144:145], v[130:131] op_sel:[0,1] op_sel_hi:[1,1]
    v_pk_mul_f32 v[148:149], v[148:149], v[130:131] op_sel:[0,1] op_sel_hi:[1,1]
    v_pk_mul_f32 v[152:153], v[152:153], v[130:131] op_sel:[0,1] op_sel_hi:[1,1]
    v_pk_mul_f32 v[156:157], v[156:157], v[130:131] op_sel:[0,1] op_sel_hi:[1,1]
    v_cvt_pk_bf16_f32 v81, v140, v141
    v_cvt_pk_bf16_f32 v82, v144, v145
    v_cvt_pk_bf16_f32 v83, v148, v149
    v_cvt_pk_bf16_f32 v84, v152, v153
    v_cvt_pk_bf16_f32 v85, v156, v157
    s_cmp_eq_u32 s19, 0
    s_cbranch_scc1 D_slow6
    buffer_store_dwordx2 v[76:77], v8, s[24:27], s62 offen
    s_add_u32 s62, s62, 4096
    buffer_store_dwordx2 v[78:79], v8, s[24:27], s62 offen
    s_add_u32 s62, s62, 4096
    buffer_store_dwordx2 v[80:81], v8, s[24:27], s62 offen
    s_add_u32 s62, s62, 4096
    buffer_store_dwordx2 v[82:83], v8, s[24:27], s62 offen
    s_add_u32 s62, s62, 4096
    buffer_store_dwordx2 v[84:85], v8, s[24:27], s62 offen
    s_add_u32 s62, s62, 4096
    s_branch D_end6
D_slow6:
    buffer_store_dwordx2 v[76:77], v8, s[24:27], s62 offen sc1
    s_add_u32 s62, s62, 4096
    buffer_store_dwordx2 v[78:79], v8, s[24:27], s62 offen sc1
    s_add_u32 s62, s62, 4096
    buffer_store_dwordx2 v[80:81], v8, s[24:27], s62 offen sc1
    s_add_u32 s62, s62, 4096
    buffer_store_dwordx2 v[82:83], v8, s[24:27], s62 offen sc1
    s_add_u32 s62, s62, 4096
    buffer_store_dwordx2 v[84:85], v8, s[24:27], s62 offen sc1
    s_add_u32 s62, s62, 4096
D_end6:
    s_waitcnt vmcnt(0)
F_l_done:
    s_nop 7
    s_nop 7
    s_barrier
    s_cmp_lg_u32 s50, 0
    s_cbranch_scc1 F_sig0
    s_add_u32 s57, s56, 0
    s_lshl_b32 s58, s49, 2
    s_add_u32 s57, s57, s58
    v_mov_b32 v12, 0
    v_mov_b32 v13, 1
    v_cmp_eq_u32 vcc, 0, v0
    s_nop 0
    s_and_saveexec_b64 s[58:59], vcc
    s_cmp_eq_u32 s19, 0
    s_cbranch_scc1 D_slow7
    buffer_store_dword v13, v12, s[24:27], s57 offen
    s_branch D_end7
D_slow7:
    buffer_store_dword v13, v12, s[24:27], s57 offen sc1
D_end7:
    s_mov_b64 exec, s[58:59]
F_sig0:
    s_add_u32 s57, s56, 0
    v_and_b32 v12, 15, v0
    v_lshlrev_b32 v12, 2, v12
    s_mov_b32 s58, 0
F_w0_poll:
    buffer_load_dword v13, v12, s[24:27], s57 offen sc1
    s_waitcnt vmcnt(0)
    v_cmp_ne_u32 vcc, 1, v13
    s_nop 1
    s_cmp_eq_u64 vcc, 0
    s_cbranch_scc1 F_w0_ok
    s_sleep 1
    s_add_u32 s58, s58, 1
    s_cmp_lt_u32 s58, 200000
    s_cbranch_scc1 F_w0_poll
F_w0_ok:
    s_nop 7
    s_nop 7
    s_lshl_b32 s60, s48, 3
    s_lshl_b32 s61, s50, 1
    s_add_u32 s60, s60, s61
    s_mul_i32 s62, s60, 20480
    s_add_u32 s62, s62, s53
    s_add_u32 s63, s62, 20480
    buffer_load_dwordx4 v[64:67], v9, s[24:27], s62 offen offset:0 sc1 nt
    buffer_load_dwordx4 v[68:71], v9, s[24:27], s63 offen offset:0 sc1 nt
    buffer_load_dwordx4 v[72:75], v9, s[24:27], s62 offen offset:1024 sc1 nt
    buffer_load_dwordx4 v[76:79], v9, s[24:27], s63 offen offset:1024 sc1 nt
    buffer_load_dwordx4 v[80:83], v9, s[24:27], s62 offen offset:2048 sc1 nt
    buffer_load_dwordx4 v[84:87], v9, s[24:27], s63 offen offset:2048 sc1 nt
    buffer_load_dwordx4 v[88:91], v9, s[24:27], s62 offen offset:3072 sc1 nt
    buffer_load_dwordx4 v[92:95], v9, s[24:27], s63 offen offset:3072 sc1 nt
    s_add_u32 s62, s62, 4096
    s_add_u32 s63, s63, 4096
    buffer_load_dwordx4 v[96:99], v9, s[24:27], s62 offen offset:0 sc1 nt
    buffer_load_dwordx4 v[100:103], v9, s[24:27], s63 offen offset:0 sc1 nt
    buffer_load_dwordx4 v[104:107], v9, s[24:27], s62 offen offset:1024 sc1 nt
    buffer_load_dwordx4 v[108:111], v9, s[24:27], s63 offen offset:1024 sc1 nt
    buffer_load_dwordx4 v[112:115], v9, s[24:27], s62 offen offset:2048 sc1 nt
    buffer_load_dwordx4 v[116:119], v9, s[24:27], s63 offen offset:2048 sc1 nt
    buffer_load_dwordx4 v[120:123], v9, s[24:27], s62 offen offset:3072 sc1 nt
    buffer_load_dwordx4 v[124:127], v9, s[24:27], s63 offen offset:3072 sc1 nt
    s_add_u32 s62, s62, 4096
    s_add_u32 s63, s63, 4096
    buffer_load_dwordx4 v[128:131], v9, s[24:27], s62 offen offset:0 sc1 nt
    buffer_load_dwordx4 v[132:135], v9, s[24:27], s63 offen offset:0 sc1 nt
    buffer_load_dwordx4 v[136:139], v9, s[24:27], s62 offen offset:1024 sc1 nt
    buffer_load_dwordx4 v[140:143], v9, s[24:27], s63 offen offset:1024 sc1 nt
    buffer_load_dwordx4 v[144:147], v9, s[24:27], s62 offen offset:2048 sc1 nt
    buffer_load_dwordx4 v[148:151], v9, s[24:27], s63 offen offset:2048 sc1 nt
    buffer_load_dwordx4 v[152:155], v9, s[24:27], s62 offen offset:3072 sc1 nt
    buffer_load_dwordx4 v[156:159], v9, s[24:27], s63 offen offset:3072 sc1 nt
    s_add_u32 s62, s62, 4096
    s_add_u32 s63, s63, 4096
    v_and_b32 v12, 15, v0
    v_mul_u32_u24 v14, 1280, v12
    v_bfe_u32 v13, v0, 4, 2
    v_lshl_add_u32 v14, v13, 3, v14
    s_lshr_b32 s40, s49, 3
    s_and_b32 s43, s49, 7
    s_lshl_b32 s41, s48, 3
    s_lshl_b32 s40, s40, 2
    s_add_u32 s40, s40, s41
    s_add_u32 s41, s40, s50
    s_mul_i32 s41, s41, 20480
    s_mul_i32 s42, s43, 160
    s_add_u32 s55, s41, s42
    s_add_u32 s45, s55, s52
    v_add_u32 v10, 57344, v9
    v_add_u32 v11, 114688, v9
    s_cmp_lg_u32 s51, 0
    s_cbranch_scc1 F_kloop1
    ds_read_b128 v[216:219], v9 offset:0
    ds_read_b128 v[220:223], v9 offset:1024
    ds_read_b128 v[224:227], v9 offset:2048
    ds_read_b128 v[228:231], v9 offset:3072
    ds_read_b128 v[232:235], v9 offset:4096
    ds_read_b128 v[236:239], v9 offset:5120
    ds_read_b128 v[240:243], v9 offset:6144
    ds_read_b128 v[244:247], v9 offset:7168
    ds_read_b128 v[248:251], v9 offset:8192
    s_waitcnt vmcnt(22) lgkmcnt(8)
    v_mfma_f32_16x16x32_bf16 v[160:163], v[216:219], v[64:67], 0
    v_mfma_f32_16x16x32_bf16 v[164:167], v[216:219], v[68:71], 0
    ds_read_b128 v[252:255], v9 offset:9216
    s_waitcnt lgkmcnt(8)
    v_mfma_f32_16x16x32_bf16 v[168:171], v[220:223], v[64:67], 0
    v_mfma_f32_16x16x32_bf16 v[172:175], v[220:223], v[68:71], 0
    ds_read_b128 v[216:219], v9 offset:10240
    s_waitcnt lgkmcnt(8)
    v_mfma_f32_16x16x32_bf16 v[176:179], v[224:227], v[64:67], 0
    v_mfma_f32_16x16x32_bf16 v[180:183], v[224:227], v[68:71], 0
    ds_read_b128 v[220:223], v9 offset:11264
    s_waitcnt lgkmcnt(8)
    v_mfma_f32_16x16x32_bf16 v[184:187], v[228:231], v[64:67], 0
    v_mfma_f32_16x16x32_bf16 v[188:191], v[228:231], v[68:71], 0
    ds_read_b128 v[224:227], v9 offset:12288
    s_waitcnt lgkmcnt(8)
    v_mfma_f32_16x16x32_bf16 v[192:195], v[232:235], v[64:67], 0
    v_mfma_f32_16x16x32_bf16 v[196:199], v[232:235], v[68:71], 0
    ds_read_b128 v[228:231], v9 offset:13312
    s_waitcnt lgkmcnt(8)
    v_mfma_f32_16x16x32_bf16 v[200:203], v[236:239], v[64:67], 0
    v_mfma_f32_16x16x32_bf16 v[204:207], v[236:239], v[68:71], 0
    ds_read_b128 v[232:235], v9 offset:14336
    s_waitcnt lgkmcnt(8)
    v_mfma_f32_16x16x32_bf16 v[208:211], v[240:243], v[64:67], 0
    v_mfma_f32_16x16x32_bf16 v[212:215], v[240:243], v[68:71], 0
    buffer_load_dwordx4 v[64:67], v9, s[24:27], s62 offen offset:0 sc1 nt
    buffer_load_dwordx4 v[68:71], v9, s[24:27], s63 offen offset:0 sc1 nt
    buffer_load_dwordx4 a[96:99], v9, s[24:27], s65 offen offset:0
    ds_read_b128 v[236:239], v9 offset:15360
    s_waitcnt vmcnt(23) lgkmcnt(8)
    v_mfma_f32_16x16x32_bf16 v[160:163], v[244:247], v[72:75], v[160:163]
    v_mfma_f32_16x16x32_bf16 v[164:167], v[244:247], v[76:79], v[164:167]
    ds_read_b128 v[240:243], v9 offset:16384
    s_waitcnt lgkmcnt(8)
    v_mfma_f32_16x16x32_bf16 v[168:171], v[248:251], v[72:75], v[168:171]
    v_mfma_f32_16x16x32_bf16 v[172:175], v[248:251], v[76:79], v[172:175]
    ds_read_b128 v[244:247], v9 offset:17408
    s_waitcnt lgkmcnt(8)
    v_mfma_f32_16x16x32_bf16 v[176:179], v[252:255], v[72:75], v[176:179]
    v_mfma_f32_16x16x32_bf16 v[180:183], v[252:255], v[76:79], v[180:183]
    ds_read_b128 v[248:251], v9 offset:18432
    s_waitcnt lgkmcnt(8)
    v_mfma_f32_16x16x32_bf16 v[184:187], v[216:219], v[72:75], v[184:187]
    v_mfma_f32_16x16x32_bf16 v[188:191], v[216:219], v[76:79], v[188:191]
    ds_read_b128 v[252:255], v9 offset:19456
    s_waitcnt lgkmcnt(8)
    v_mfma_f32_16x16x32_bf16 v[192:195], v[220:223], v[72:75], v[192:195]
    v_mfma_f32_16x16x32_bf16 v[196:199], v[220:223], v[76:79], v[196:199]
    ds_read_b128 v[216:219], v9 offset:20480
    s_waitcnt lgkmcnt(8)
    v_mfma_f32_16x16x32_bf16 v[200:203], v[224:227], v[72:75], v[200:203]
    v_mfma_f32_16x16x32_bf16 v[204:207], v[224:227], v[76:79], v[204:207]
    ds_read_b128 v[220:223], v9 offset:21504
    s_waitcnt lgkmcnt(8)
    v_mfma_f32_16x16x32_bf16 v[208:211], v[228:231], v[72:75], v[208:211]
    v_mfma_f32_16x16x32_bf16 v[212:215], v[228:231], v[76:79], v[212:215]
    buffer_load_dwordx4 v[72:75], v9, s[24:27], s62 offen offset:1024 sc1 nt
    buffer_load_dwordx4 v[76:79], v9, s[24:27], s63 offen offset:1024 sc1 nt
    buffer_load_dwordx4 a[100:103], v9, s[24:27], s65 offen offset:1024
    buffer_load_dwordx4 a[104:107], v9, s[24:27], s65 offen offset:2048
    ds_read_b128 v[224:227], v9 offset:22528
    s_waitcnt vmcnt(25) lgkmcnt(8)
    v_mfma_f32_16x16x32_bf16 v[160:163], v[232:235], v[80:83], v[160:163]
    v_mfma_f32_16x16x32_bf16 v[164:167], v[232:235], v[84:87], v[164:167]
    ds_read_b128 v[228:231], v9 offset:23552
    s_waitcnt lgkmcnt(8)
    v_mfma_f32_16x16x32_bf16 v[168:171], v[236:239], v[80:83], v[168:171]
    v_mfma_f32_16x16x32_bf16 v[172:175], v[236:239], v[84:87], v[172:175]
    ds_read_b128 v[232:235], v9 offset:24576
    s_waitcnt lgkmcnt(8)
    v_mfma_f32_16x16x32_bf16 v[176:179], v[240:243], v[80:83], v[176:179]
    v_mfma_f32_16x16x32_bf16 v[180:183], v[240:243], v[84:87], v[180:183]
    ds_read_b128 v[236:239], v9 offset:25600
    s_waitcnt lgkmcnt(8)
    v_mfma_f32_16x16x32_bf16 v[184:187], v[244:247], v[80:83], v[184:187]
    v_mfma_f32_16x16x32_bf16 v[188:191], v[244:247], v[84:87], v[188:191]
    ds_read_b128 v[240:243], v9 offset:26624
    s_waitcnt lgkmcnt(8)
    v_mfma_f32_16x16x32_bf16 v[192:195], v[248:251], v[80:83], v[192:195]
    v_mfma_f32_16x16x32_bf16 v[196:199], v[248:251], v[84:87], v[196:199]
    ds_read_b128 v[244:247], v9 offset:27648
    s_waitcnt lgkmcnt(8)
    v_mfma_f32_16x16x32_bf16 v[200:203], v[252:255], v[80:83], v[200:203]
    v_mfma_f32_16x16x32_bf16 v[204:207], v[252:255], v[84:87], v[204:207]
    ds_read_b128 v[248:251], v9 offset:28672
    s_waitcnt lgkmcnt(8)
    v_mfma_f32_16x16x32_bf16 v[208:211], v[216:219], v[80:83], v[208:211]
    v_mfma_f32_16x16x32_bf16 v[212:215], v[216:219], v[84:87], v[212:215]
    buffer_load_dwordx4 v[80:83], v9, s[24:27], s62 offen offset:2048 sc1 nt
    buffer_load_dwordx4 v[84:87], v9, s[24:27], s63 offen offset:2048 sc1 nt
    buffer_load_dwordx4 a[108:111], v9, s[24:27], s65 offen offset:3072
    s_add_u32 s65, s65, 4096
    ds_read_b128 v[252:255], v9 offset:29696
    s_waitcnt vmcnt(26) lgkmcnt(8)
    v_mfma_f32_16x16x32_bf16 v[160:163], v[220:223], v[88:91], v[160:163]
    v_mfma_f32_16x16x32_bf16 v[164:167], v[220:223], v[92:95], v[164:167]
    ds_read_b128 v[216:219], v9 offset:30720
    s_waitcnt lgkmcnt(8)
    v_mfma_f32_16x16x32_bf16 v[168:171], v[224:227], v[88:91], v[168:171]
    v_mfma_f32_16x16x32_bf16 v[172:175], v[224:227], v[92:95], v[172:175]
    ds_read_b128 v[220:223], v9 offset:31744
    s_waitcnt lgkmcnt(8)
    v_mfma_f32_16x16x32_bf16 v[176:179], v[228:231], v[88:91], v[176:179]
    v_mfma_f32_16x16x32_bf16 v[180:183], v[228:231], v[92:95], v[180:183]
    ds_read_b128 v[224:227], v9 offset:32768
    s_waitcnt lgkmcnt(8)
    v_mfma_f32_16x16x32_bf16 v[184:187], v[232:235], v[88:91], v[184:187]
    v_mfma_f32_16x16x32_bf16 v[188:191], v[232:235], v[92:95], v[188:191]
    ds_read_b128 v[228:231], v9 offset:33792
    s_waitcnt lgkmcnt(8)
    v_mfma_f32_16x16x32_bf16 v[192:195], v[236:239], v[88:91], v[192:195]
    v_mfma_f32_16x16x32_bf16 v[196:199], v[236:239], v[92:95], v[196:199]
    ds_read_b128 v[232:235], v9 offset:34816
    s_waitcnt lgkmcnt(8)
    v_mfma_f32_16x16x32_bf16 v[200:203], v[240:243], v[88:91], v[200:203]
    v_mfma_f32_16x16x32_bf16 v[204:207], v[240:243], v[92:95], v[204:207]
    ds_read_b128 v[236:239], v9 offset:35840
    s_waitcnt lgkmcnt(8)
    v_mfma_f32_16x16x32_bf16 v[208:211], v[244:247], v[88:91], v[208:211]
    v_mfma_f32_16x16x32_bf16 v[212:215], v[244:247], v[92:95], v[212:215]
    buffer_load_dwordx4 v[88:91], v9, s[24:27], s62 offen offset:3072 sc1 nt
    buffer_load_dwordx4 v[92:95], v9, s[24:27], s63 offen offset:3072 sc1 nt
    s_add_u32 s62, s62, 4096
    s_add_u32 s63, s63, 4096
    buffer_load_dwordx4 a[112:115], v9, s[24:27], s65 offen offset:0
    buffer_load_dwordx4 a[116:119], v9, s[24:27], s65 offen offset:1024
    ds_read_b128 v[240:243], v9 offset:36864
    s_waitcnt vmcnt(28) lgkmcnt(8)
    v_mfma_f32_16x16x32_bf16 v[160:163], v[248:251], v[96:99], v[160:163]
    v_mfma_f32_16x16x32_bf16 v[164:167], v[248:251], v[100:103], v[164:167]
    ds_read_b128 v[244:247], v9 offset:37888
    s_waitcnt lgkmcnt(8)
    v_mfma_f32_16x16x32_bf16 v[168:171], v[252:255], v[96:99], v[168:171]
    v_mfma_f32_16x16x32_bf16 v[172:175], v[252:255], v[100:103], v[172:175]
    ds_read_b128 v[248:251], v9 offset:38912
    s_waitcnt lgkmcnt(8)
    v_mfma_f32_16x16x32_bf16 v[176:179], v[216:219], v[96:99], v[176:179]
    v_mfma_f32_16x16x32_bf16 v[180:183], v[216:219], v[100:103], v[180:183]
    ds_read_b128 v[252:255], v9 offset:39936
    s_waitcnt lgkmcnt(8)
    v_mfma_f32_16x16x32_bf16 v[184:187], v[220:223], v[96:99], v[184:187]
    v_mfma_f32_16x16x32_bf16 v[188:191], v[220:223], v[100:103], v[188:191]
    ds_read_b128 v[216:219], v9 offset:40960
    s_waitcnt lgkmcnt(8)
    v_mfma_f32_16x16x32_bf16 v[192:195], v[224:227], v[96:99], v[192:195]
    v_mfma_f32_16x16x32_bf16 v[196:199], v[224:227], v[100:103], v[196:199]
    ds_read_b128 v[220:223], v9 offset:41984
    s_waitcnt lgkmcnt(8)
    v_mfma_f32_16x16x32_bf16 v[200:203], v[228:231], v[96:99], v[200:203]
    v_mfma_f32_16x16x32_bf16 v[204:207], v[228:231], v[100:103], v[204:207]
    ds_read_b128 v[224:227], v9 offset:43008
    s_waitcnt lgkmcnt(8)
    v_mfma_f32_16x16x32_bf16 v[208:211], v[232:235], v[96:99], v[208:211]
    v_mfma_f32_16x16x32_bf16 v[212:215], v[232:235], v[100:103], v[212:215]
    buffer_load_dwordx4 v[96:99], v9, s[24:27], s62 offen offset:0 sc1 nt
    buffer_load_dwordx4 v[100:103], v9, s[24:27], s63 offen offset:0 sc1 nt
    buffer_load_dwordx4 a[120:123], v9, s[24:27], s65 offen offset:2048
    ds_read_b128 v[228:231], v9 offset:44032
    s_waitcnt vmcnt(29) lgkmcnt(8)
    v_mfma_f32_16x16x32_bf16 v[160:163], v[236:239], v[104:107], v[160:163]
    v_mfma_f32_16x16x32_bf16 v[164:167], v[236:239], v[108:111], v[164:167]
    ds_read_b128 v[232:235], v9 offset:45056
    s_waitcnt lgkmcnt(8)
    v_mfma_f32_16x16x32_bf16 v[168:171], v[240:243], v[104:107], v[168:171]
    v_mfma_f32_16x16x32_bf16 v[172:175], v[240:243], v[108:111], v[172:175]
    ds_read_b128 v[236:239], v9 offset:46080
    s_waitcnt lgkmcnt(8)
    v_mfma_f32_16x16x32_bf16 v[176:179], v[244:247], v[104:107], v[176:179]
    v_mfma_f32_16x16x32_bf16 v[180:183], v[244:247], v[108:111], v[180:183]
    ds_read_b128 v[240:243], v9 offset:47104
    s_waitcnt lgkmcnt(8)
    v_mfma_f32_16x16x32_bf16 v[184:187], v[248:251], v[104:107], v[184:187]
    v_mfma_f32_16x16x32_bf16 v[188:191], v[248:251], v[108:111], v[188:191]
    ds_read_b128 v[244:247], v9 offset:48128
    s_waitcnt lgkmcnt(8)
    v_mfma_f32_16x16x32_bf16 v[192:195], v[252:255], v[104:107], v[192:195]
    v_mfma_f32_16x16x32_bf16 v[196:199], v[252:255], v[108:111], v[196:199]
    ds_read_b128 v[248:251], v9 offset:49152
    s_waitcnt lgkmcnt(8)
    v_mfma_f32_16x16x32_bf16 v[200:203], v[216:219], v[104:107], v[200:203]
    v_mfma_f32_16x16x32_bf16 v[204:207], v[216:219], v[108:111], v[204:207]
    ds_read_b128 v[252:255], v9 offset:50176
    s_waitcnt lgkmcnt(8)
    v_mfma_f32_16x16x32_bf16 v[208:211], v[220:223], v[104:107], v[208:211]
    v_mfma_f32_16x16x32_bf16 v[212:215], v[220:223], v[108:111], v[212:215]
    buffer_load_dwordx4 v[104:107], v9, s[24:27], s62 offen offset:1024 sc1 nt
    buffer_load_dwordx4 v[108:111], v9, s[24:27], s63 offen offset:1024 sc1 nt
    buffer_load_dwordx4 a[124:127], v9, s[24:27], s65 offen offset:3072
    s_add_u32 s65, s65, 4096
    buffer_load_dwordx4 a[128:131], v9, s[24:27], s65 offen offset:0
    ds_read_b128 v[216:219], v9 offset:51200
    s_waitcnt vmcnt(31) lgkmcnt(8)
    v_mfma_f32_16x16x32_bf16 v[160:163], v[224:227], v[112:115], v[160:163]
    v_mfma_f32_16x16x32_bf16 v[164:167], v[224:227], v[116:119], v[164:167]
    ds_read_b128 v[220:223], v9 offset:52224
    s_waitcnt lgkmcnt(8)
    v_mfma_f32_16x16x32_bf16 v[168:171], v[228:231], v[112:115], v[168:171]
    v_mfma_f32_16x16x32_bf16 v[172:175], v[228:231], v[116:119], v[172:175]
    ds_read_b128 v[224:227], v9 offset:53248
    s_waitcnt lgkmcnt(8)
    v_mfma_f32_16x16x32_bf16 v[176:179], v[232:235], v[112:115], v[176:179]
    v_mfma_f32_16x16x32_bf16 v[180:183], v[232:235], v[116:119], v[180:183]
    ds_read_b128 v[228:231], v9 offset:54272
    s_waitcnt lgkmcnt(8)
    v_mfma_f32_16x16x32_bf16 v[184:187], v[236:239], v[112:115], v[184:187]
    v_mfma_f32_16x16x32_bf16 v[188:191], v[236:239], v[116:119], v[188:191]
    ds_read_b128 v[232:235], v9 offset:55296
    s_waitcnt lgkmcnt(8)
    v_mfma_f32_16x16x32_bf16 v[192:195], v[240:243], v[112:115], v[192:195]
    v_mfma_f32_16x16x32_bf16 v[196:199], v[240:243], v[116:119], v[196:199]
    ds_read_b128 v[236:239], v9 offset:56320
    s_waitcnt lgkmcnt(8)
    v_mfma_f32_16x16x32_bf16 v[200:203], v[244:247], v[112:115], v[200:203]
    v_mfma_f32_16x16x32_bf16 v[204:207], v[244:247], v[116:119], v[204:207]
    ds_read_b128 v[240:243], v10 offset:0
    s_waitcnt lgkmcnt(8)
    v_mfma_f32_16x16x32_bf16 v[208:211], v[248:251], v[112:115], v[208:211]
    v_mfma_f32_16x16x32_bf16 v[212:215], v[248:251], v[116:119], v[212:215]
    buffer_load_dwordx4 v[112:115], v9, s[24:27], s62 offen offset:2048 sc1 nt
    buffer_load_dwordx4 v[116:119], v9, s[24:27], s63 offen offset:2048 sc1 nt
    buffer_load_dwordx4 a[132:135], v9, s[24:27], s65 offen offset:1024
    ds_read_b128 v[244:247], v10 offset:1024
    s_waitcnt vmcnt(32) lgkmcnt(8)
    v_mfma_f32_16x16x32_bf16 v[160:163], v[252:255], v[120:123], v[160:163]
    v_mfma_f32_16x16x32_bf16 v[164:167], v[252:255], v[124:127], v[164:167]
    ds_read_b128 v[248:251], v10 offset:2048
    s_waitcnt lgkmcnt(8)
    v_mfma_f32_16x16x32_bf16 v[168:171], v[216:219], v[120:123], v[168:171]
    v_mfma_f32_16x16x32_bf16 v[172:175], v[216:219], v[124:127], v[172:175]
    ds_read_b128 v[252:255], v10 offset:3072
    s_waitcnt lgkmcnt(8)
    v_mfma_f32_16x16x32_bf16 v[176:179], v[220:223], v[120:123], v[176:179]
    v_mfma_f32_16x16x32_bf16 v[180:183], v[220:223], v[124:127], v[180:183]
    ds_read_b128 v[216:219], v10 offset:4096
    s_waitcnt lgkmcnt(8)
    v_mfma_f32_16x16x32_bf16 v[184:187], v[224:227], v[120:123], v[184:187]
    v_mfma_f32_16x16x32_bf16 v[188:191], v[224:227], v[124:127], v[188:191]
    ds_read_b128 v[220:223], v10 offset:5120
    s_waitcnt lgkmcnt(8)
    v_mfma_f32_16x16x32_bf16 v[192:195], v[228:231], v[120:123], v[192:195]
    v_mfma_f32_16x16x32_bf16 v[196:199], v[228:231], v[124:127], v[196:199]
    ds_read_b128 v[224:227], v10 offset:6144
    s_waitcnt lgkmcnt(8)
    v_mfma_f32_16x16x32_bf16 v[200:203], v[232:235], v[120:123], v[200:203]
    v_mfma_f32_16x16x32_bf16 v[204:207], v[232:235], v[124:127], v[204:207]
    ds_read_b128 v[228:231], v10 offset:7168
    s_waitcnt lgkmcnt(8)
    v_mfma_f32_16x16x32_bf16 v[208:211], v[236:239], v[120:123], v[208:211]
    v_mfma_f32_16x16x32_bf16 v[212:215], v[236:239], v[124:127], v[212:215]
    buffer_load_dwordx4 v[120:123], v9, s[24:27], s62 offen offset:3072 sc1 nt
    buffer_load_dwordx4 v[124:127], v9, s[24:27], s63 offen offset:3072 sc1 nt
    s_add_u32 s62, s62, 4096
    s_add_u32 s63, s63, 4096
    buffer_load_dwordx4 a[136:139], v9, s[24:27], s65 offen offset:2048
    buffer_load_dwordx4 a[140:143], v9, s[24:27], s65 offen offset:3072
    s_add_u32 s65, s65, 4096
    ds_read_b128 v[232:235], v10 offset:8192
    s_waitcnt vmcnt(34) lgkmcnt(8)
    v_mfma_f32_16x16x32_bf16 v[160:163], v[240:243], v[128:131], v[160:163]
    v_mfma_f32_16x16x32_bf16 v[164:167], v[240:243], v[132:135], v[164:167]
    ds_read_b128 v[236:239], v10 offset:9216
    s_waitcnt lgkmcnt(8)
    v_mfma_f32_16x16x32_bf16 v[168:171], v[244:247], v[128:131], v[168:171]
    v_mfma_f32_16x16x32_bf16 v[172:175], v[244:247], v[132:135], v[172:175]
    ds_read_b128 v[240:243], v10 offset:10240
    s_waitcnt lgkmcnt(8)
    v_mfma_f32_16x16x32_bf16 v[176:179], v[248:251], v[128:131], v[176:179]
    v_mfma_f32_16x16x32_bf16 v[180:183], v[248:251], v[132:135], v[180:183]
    ds_read_b128 v[244:247], v10 offset:11264
    s_waitcnt lgkmcnt(8)
    v_mfma_f32_16x16x32_bf16 v[184:187], v[252:255], v[128:131], v[184:187]
    v_mfma_f32_16x16x32_bf16 v[188:191], v[252:255], v[132:135], v[188:191]
    ds_read_b128 v[248:251], v10 offset:12288
    s_waitcnt lgkmcnt(8)
    v_mfma_f32_16x16x32_bf16 v[192:195], v[216:219], v[128:131], v[192:195]
    v_mfma_f32_16x16x32_bf16 v[196:199], v[216:219], v[132:135], v[196:199]
    ds_read_b128 v[252:255], v10 offset:13312
    s_waitcnt lgkmcnt(8)
    v_mfma_f32_16x16x32_bf16 v[200:203], v[220:223], v[128:131], v[200:203]
    v_mfma_f32_16x16x32_bf16 v[204:207], v[220:223], v[132:135], v[204:207]
    ds_read_b128 v[216:219], v10 offset:14336
    s_waitcnt lgkmcnt(8)
    v_mfma_f32_16x16x32_bf16 v[208:211], v[224:227], v[128:131], v[208:211]
    v_mfma_f32_16x16x32_bf16 v[212:215], v[224:227], v[132:135], v[212:215]
    buffer_load_dwordx4 a[144:147], v9, s[24:27], s65 offen offset:0
    ds_read_b128 v[220:223], v10 offset:15360
    s_waitcnt vmcnt(33) lgkmcnt(8)
    v_mfma_f32_16x16x32_bf16 v[160:163], v[228:231], v[136:139], v[160:163]
    v_mfma_f32_16x16x32_bf16 v[164:167], v[228:231], v[140:143], v[164:167]
    ds_read_b128 v[224:227], v10 offset:16384
    s_waitcnt lgkmcnt(8)
    v_mfma_f32_16x16x32_bf16 v[168:171], v[232:235], v[136:139], v[168:171]
    v_mfma_f32_16x16x32_bf16 v[172:175], v[232:235], v[140:143], v[172:175]
    ds_read_b128 v[228:231], v10 offset:17408
    s_waitcnt lgkmcnt(8)
    v_mfma_f32_16x16x32_bf16 v[176:179], v[236:239], v[136:139], v[176:179]
    v_mfma_f32_16x16x32_bf16 v[180:183], v[236:239], v[140:143], v[180:183]
    ds_read_b128 v[232:235], v10 offset:18432
    s_waitcnt lgkmcnt(8)
    v_mfma_f32_16x16x32_bf16 v[184:187], v[240:243], v[136:139], v[184:187]
    v_mfma_f32_16x16x32_bf16 v[188:191], v[240:243], v[140:143], v[188:191]
    ds_read_b128 v[236:239], v10 offset:19456
    s_waitcnt lgkmcnt(8)
    v_mfma_f32_16x16x32_bf16 v[192:195], v[244:247], v[136:139], v[192:195]
    v_mfma_f32_16x16x32_bf16 v[196:199], v[244:247], v[140:143], v[196:199]
    ds_read_b128 v[240:243], v10 offset:20480
    s_waitcnt lgkmcnt(8)
    v_mfma_f32_16x16x32_bf16 v[200:203], v[248:251], v[136:139], v[200:203]
    v_mfma_f32_16x16x32_bf16 v[204:207], v[248:251], v[140:143], v[204:207]
    ds_read_b128 v[244:247], v10 offset:21504
    s_waitcnt lgkmcnt(8)
    v_mfma_f32_16x16x32_bf16 v[208:211], v[252:255], v[136:139], v[208:211]
    v_mfma_f32_16x16x32_bf16 v[212:215], v[252:255], v[140:143], v[212:215]
    buffer_load_dwordx2 v[16:17], v14, s[24:27], s45 offen offset:0 sc1 nt
    buffer_load_dwordx2 v[18:19], v14, s[24:27], s45 offen offset:32 sc1 nt
    buffer_load_dwordx2 v[20:21], v14, s[24:27], s45 offen offset:64 sc1 nt
    buffer_load_dwordx2 v[22:23], v14, s[24:27], s45 offen offset:96 sc1 nt
    buffer_load_dwordx2 v[24:25], v14, s[24:27], s45 offen offset:128 sc1 nt
    buffer_load_dwordx4 a[148:151], v9, s[24:27], s65 offen offset:1024
    buffer_load_dwordx4 a[152:155], v9, s[24:27], s65 offen offset:2048
    ds_read_b128 v[248:251], v10 offset:22528
    s_waitcnt vmcnt(38) lgkmcnt(8)
    v_mfma_f32_16x16x32_bf16 v[160:163], v[216:219], v[144:147], v[160:163]
    v_mfma_f32_16x16x32_bf16 v[164:167], v[216:219], v[148:151], v[164:167]
    ds_read_b128 v[252:255], v10 offset:23552
    s_waitcnt lgkmcnt(8)
    v_mfma_f32_16x16x32_bf16 v[168:171], v[220:223], v[144:147], v[168:171]
    v_mfma_f32_16x16x32_bf16 v[172:175], v[220:223], v[148:151], v[172:175]
    ds_read_b128 v[216:219], v10 offset:24576
    s_waitcnt lgkmcnt(8)
    v_mfma_f32_16x16x32_bf16 v[176:179], v[224:227], v[144:147], v[176:179]
    v_mfma_f32_16x16x32_bf16 v[180:183], v[224:227], v[148:151], v[180:183]
    ds_read_b128 v[220:223], v10 offset:25600
    s_waitcnt lgkmcnt(8)
    v_mfma_f32_16x16x32_bf16 v[184:187], v[228:231], v[144:147], v[184:187]
    v_mfma_f32_16x16x32_bf16 v[188:191], v[228:231], v[148:151], v[188:191]
    ds_read_b128 v[224:227], v10 offset:26624
    s_waitcnt lgkmcnt(8)
    v_mfma_f32_16x16x32_bf16 v[192:195], v[232:235], v[144:147], v[192:195]
    v_mfma_f32_16x16x32_bf16 v[196:199], v[232:235], v[148:151], v[196:199]
    ds_read_b128 v[228:231], v10 offset:27648
    s_waitcnt lgkmcnt(8)
    v_mfma_f32_16x16x32_bf16 v[200:203], v[236:239], v[144:147], v[200:203]
    v_mfma_f32_16x16x32_bf16 v[204:207], v[236:239], v[148:151], v[204:207]
    ds_read_b128 v[232:235], v10 offset:28672
    s_waitcnt lgkmcnt(8)
    v_mfma_f32_16x16x32_bf16 v[208:211], v[240:243], v[144:147], v[208:211]
    v_mfma_f32_16x16x32_bf16 v[212:215], v[240:243], v[148:151], v[212:215]
    buffer_load_dwordx4 a[156:159], v9, s[24:27], s65 offen offset:3072
    s_add_u32 s65, s65, 4096
    ds_read_b128 v[236:239], v10 offset:29696
    s_waitcnt vmcnt(37) lgkmcnt(8)
    v_mfma_f32_16x16x32_bf16 v[160:163], v[244:247], v[152:155], v[160:163]
    v_mfma_f32_16x16x32_bf16 v[164:167], v[244:247], v[156:159], v[164:167]
    ds_read_b128 v[240:243], v10 offset:30720
    s_waitcnt lgkmcnt(8)
    v_mfma_f32_16x16x32_bf16 v[168:171], v[248:251], v[152:155], v[168:171]
    v_mfma_f32_16x16x32_bf16 v[172:175], v[248:251], v[156:159], v[172:175]
    ds_read_b128 v[244:247], v10 offset:31744
    s_waitcnt lgkmcnt(8)
    v_mfma_f32_16x16x32_bf16 v[176:179], v[252:255], v[152:155], v[176:179]
    v_mfma_f32_16x16x32_bf16 v[180:183], v[252:255], v[156:159], v[180:183]
    ds_read_b128 v[248:251], v10 offset:32768
    s_waitcnt lgkmcnt(8)
    v_mfma_f32_16x16x32_bf16 v[184:187], v[216:219], v[152:155], v[184:187]
    v_mfma_f32_16x16x32_bf16 v[188:191], v[216:219], v[156:159], v[188:191]
    ds_read_b128 v[252:255], v10 offset:33792
    s_waitcnt lgkmcnt(8)
    v_mfma_f32_16x16x32_bf16 v[192:195], v[220:223], v[152:155], v[192:195]
    v_mfma_f32_16x16x32_bf16 v[196:199], v[220:223], v[156:159], v[196:199]
    ds_read_b128 v[216:219], v10 offset:34816
    s_waitcnt lgkmcnt(8)
    v_mfma_f32_16x16x32_bf16 v[200:203], v[224:227], v[152:155], v[200:203]
    v_mfma_f32_16x16x32_bf16 v[204:207], v[224:227], v[156:159], v[204:207]
    ds_read_b128 v[220:223], v10 offset:35840
    s_waitcnt lgkmcnt(8)
    v_mfma_f32_16x16x32_bf16 v[208:211], v[228:231], v[152:155], v[208:211]
    v_mfma_f32_16x16x32_bf16 v[212:215], v[228:231], v[156:159], v[212:215]
    buffer_load_dwordx4 a[160:163], v9, s[24:27], s65 offen offset:0
    buffer_load_dwordx4 a[164:167], v9, s[24:27], s65 offen offset:1024
    ds_read_b128 v[224:227], v10 offset:36864
    s_waitcnt vmcnt(37) lgkmcnt(8)
    v_mfma_f32_16x16x32_bf16 v[160:163], v[232:235], v[64:67], v[160:163]
    v_mfma_f32_16x16x32_bf16 v[164:167], v[232:235], v[68:71], v[164:167]
    ds_read_b128 v[228:231], v10 offset:37888
    s_waitcnt lgkmcnt(8)
    v_mfma_f32_16x16x32_bf16 v[168:171], v[236:239], v[64:67], v[168:171]
    v_mfma_f32_16x16x32_bf16 v[172:175], v[236:239], v[68:71], v[172:175]
    ds_read_b128 v[232:235], v10 offset:38912
    s_waitcnt lgkmcnt(8)
    v_mfma_f32_16x16x32_bf16 v[176:179], v[240:243], v[64:67], v[176:179]
    v_mfma_f32_16x16x32_bf16 v[180:183], v[240:243], v[68:71], v[180:183]
    ds_read_b128 v[236:239], v10 offset:39936
    s_waitcnt lgkmcnt(8)
    v_mfma_f32_16x16x32_bf16 v[184:187], v[244:247], v[64:67], v[184:187]
    v_mfma_f32_16x16x32_bf16 v[188:191], v[244:247], v[68:71], v[188:191]
    ds_read_b128 v[240:243], v10 offset:40960
    s_waitcnt lgkmcnt(8)
    v_mfma_f32_16x16x32_bf16 v[192:195], v[248:251], v[64:67], v[192:195]
    v_mfma_f32_16x16x32_bf16 v[196:199], v[248:251], v[68:71], v[196:199]
    ds_read_b128 v[244:247], v10 offset:41984
    s_waitcnt lgkmcnt(8)
    v_mfma_f32_16x16x32_bf16 v[200:203], v[252:255], v[64:67], v[200:203]
    v_mfma_f32_16x16x32_bf16 v[204:207], v[252:255], v[68:71], v[204:207]
    ds_read_b128 v[248:251], v10 offset:43008
    s_waitcnt lgkmcnt(8)
    v_mfma_f32_16x16x32_bf16 v[208:211], v[216:219], v[64:67], v[208:211]
    v_mfma_f32_16x16x32_bf16 v[212:215], v[216:219], v[68:71], v[212:215]
    buffer_load_dwordx4 a[168:171], v9, s[24:27], s65 offen offset:2048
    ds_read_b128 v[252:255], v10 offset:44032
    s_waitcnt vmcnt(35) lgkmcnt(8)
    v_mfma_f32_16x16x32_bf16 v[160:163], v[220:223], v[72:75], v[160:163]
    v_mfma_f32_16x16x32_bf16 v[164:167], v[220:223], v[76:79], v[164:167]
    ds_read_b128 v[216:219], v10 offset:45056
    s_waitcnt lgkmcnt(8)
    v_mfma_f32_16x16x32_bf16 v[168:171], v[224:227], v[72:75], v[168:171]
    v_mfma_f32_16x16x32_bf16 v[172:175], v[224:227], v[76:79], v[172:175]
    ds_read_b128 v[220:223], v10 offset:46080
    s_waitcnt lgkmcnt(8)
    v_mfma_f32_16x16x32_bf16 v[176:179], v[228:231], v[72:75], v[176:179]
    v_mfma_f32_16x16x32_bf16 v[180:183], v[228:231], v[76:79], v[180:183]
    ds_read_b128 v[224:227], v10 offset:47104
    s_waitcnt lgkmcnt(8)
    v_mfma_f32_16x16x32_bf16 v[184:187], v[232:235], v[72:75], v[184:187]
    v_mfma_f32_16x16x32_bf16 v[188:191], v[232:235], v[76:79], v[188:191]
    ds_read_b128 v[228:231], v10 offset:48128
    s_waitcnt lgkmcnt(8)
    v_mfma_f32_16x16x32_bf16 v[192:195], v[236:239], v[72:75], v[192:195]
    v_mfma_f32_16x16x32_bf16 v[196:199], v[236:239], v[76:79], v[196:199]
    ds_read_b128 v[232:235], v10 offset:49152
    s_waitcnt lgkmcnt(8)
    v_mfma_f32_16x16x32_bf16 v[200:203], v[240:243], v[72:75], v[200:203]
    v_mfma_f32_16x16x32_bf16 v[204:207], v[240:243], v[76:79], v[204:207]
    ds_read_b128 v[236:239], v10 offset:50176
    s_waitcnt lgkmcnt(8)
    v_mfma_f32_16x16x32_bf16 v[208:211], v[244:247], v[72:75], v[208:211]
    v_mfma_f32_16x16x32_bf16 v[212:215], v[244:247], v[76:79], v[212:215]
    buffer_load_dwordx4 a[172:175], v9, s[24:27], s65 offen offset:3072
    s_add_u32 s65, s65, 4096
    buffer_load_dwordx4 a[176:179], v9, s[24:27], s65 offen offset:0
    ds_read_b128 v[240:243], v10 offset:51200
    s_waitcnt vmcnt(33) lgkmcnt(8)
    v_mfma_f32_16x16x32_bf16 v[160:163], v[248:251], v[80:83], v[160:163]
    v_mfma_f32_16x16x32_bf16 v[164:167], v[248:251], v[84:87], v[164:167]
    ds_read_b128 v[244:247], v10 offset:52224
    s_waitcnt lgkmcnt(8)
    v_mfma_f32_16x16x32_bf16 v[168:171], v[252:255], v[80:83], v[168:171]
    v_mfma_f32_16x16x32_bf16 v[172:175], v[252:255], v[84:87], v[172:175]
    ds_read_b128 v[248:251], v10 offset:53248
    s_waitcnt lgkmcnt(8)
    v_mfma_f32_16x16x32_bf16 v[176:179], v[216:219], v[80:83], v[176:179]
    v_mfma_f32_16x16x32_bf16 v[180:183], v[216:219], v[84:87], v[180:183]
    ds_read_b128 v[252:255], v10 offset:54272
    s_waitcnt lgkmcnt(8)
    v_mfma_f32_16x16x32_bf16 v[184:187], v[220:223], v[80:83], v[184:187]
    v_mfma_f32_16x16x32_bf16 v[188:191], v[220:223], v[84:87], v[188:191]
    ds_read_b128 v[216:219], v10 offset:55296
    s_waitcnt lgkmcnt(8)
    v_mfma_f32_16x16x32_bf16 v[192:195], v[224:227], v[80:83], v[192:195]
    v_mfma_f32_16x16x32_bf16 v[196:199], v[224:227], v[84:87], v[196:199]
    ds_read_b128 v[220:223], v10 offset:56320
    s_waitcnt lgkmcnt(8)
    v_mfma_f32_16x16x32_bf16 v[200:203], v[228:231], v[80:83], v[200:203]
    v_mfma_f32_16x16x32_bf16 v[204:207], v[228:231], v[84:87], v[204:207]
    ds_read_b128 v[224:227], v11 offset:0
    s_waitcnt lgkmcnt(8)
    v_mfma_f32_16x16x32_bf16 v[208:211], v[232:235], v[80:83], v[208:211]
    v_mfma_f32_16x16x32_bf16 v[212:215], v[232:235], v[84:87], v[212:215]
    buffer_load_dwordx4 a[180:183], v9, s[24:27], s65 offen offset:1024
    ds_read_b128 v[228:231], v11 offset:1024
    s_waitcnt vmcnt(31) lgkmcnt(8)
    v_mfma_f32_16x16x32_bf16 v[160:163], v[236:239], v[88:91], v[160:163]
    v_mfma_f32_16x16x32_bf16 v[164:167], v[236:239], v[92:95], v[164:167]
    ds_read_b128 v[232:235], v11 offset:2048
    s_waitcnt lgkmcnt(8)
    v_mfma_f32_16x16x32_bf16 v[168:171], v[240:243], v[88:91], v[168:171]
    v_mfma_f32_16x16x32_bf16 v[172:175], v[240:243], v[92:95], v[172:175]
    ds_read_b128 v[236:239], v11 offset:3072
    s_waitcnt lgkmcnt(8)
    v_mfma_f32_16x16x32_bf16 v[176:179], v[244:247], v[88:91], v[176:179]
    v_mfma_f32_16x16x32_bf16 v[180:183], v[244:247], v[92:95], v[180:183]
    ds_read_b128 v[240:243], v11 offset:4096
    s_waitcnt lgkmcnt(8)
    v_mfma_f32_16x16x32_bf16 v[184:187], v[248:251], v[88:91], v[184:187]
    v_mfma_f32_16x16x32_bf16 v[188:191], v[248:251], v[92:95], v[188:191]
    ds_read_b128 v[244:247], v11 offset:5120
    s_waitcnt lgkmcnt(8)
    v_mfma_f32_16x16x32_bf16 v[192:195], v[252:255], v[88:91], v[192:195]
    v_mfma_f32_16x16x32_bf16 v[196:199], v[252:255], v[92:95], v[196:199]
    ds_read_b128 v[248:251], v11 offset:6144
    s_waitcnt lgkmcnt(8)
    v_mfma_f32_16x16x32_bf16 v[200:203], v[216:219], v[88:91], v[200:203]
    v_mfma_f32_16x16x32_bf16 v[204:207], v[216:219], v[92:95], v[204:207]
    ds_read_b128 v[252:255], v11 offset:7168
    s_waitcnt lgkmcnt(8)
    v_mfma_f32_16x16x32_bf16 v[208:211], v[220:223], v[88:91], v[208:211]
    v_mfma_f32_16x16x32_bf16 v[212:215], v[220:223], v[92:95], v[212:215]
    buffer_load_dwordx4 a[184:187], v9, s[24:27], s65 offen offset:2048
    buffer_load_dwordx4 a[188:191], v9, s[24:27], s65 offen offset:3072
    s_add_u32 s65, s65, 4096
    ds_read_b128 v[216:219], v11 offset:8192
    s_waitcnt vmcnt(29) lgkmcnt(8)
    v_mfma_f32_16x16x32_bf16 v[160:163], v[224:227], v[96:99], v[160:163]
    v_mfma_f32_16x16x32_bf16 v[164:167], v[224:227], v[100:103], v[164:167]
    ds_read_b128 v[220:223], v11 offset:9216
    s_waitcnt lgkmcnt(8)
    v_mfma_f32_16x16x32_bf16 v[168:171], v[228:231], v[96:99], v[168:171]
    v_mfma_f32_16x16x32_bf16 v[172:175], v[228:231], v[100:103], v[172:175]
    ds_read_b128 v[224:227], v11 offset:10240
    s_waitcnt lgkmcnt(8)
    v_mfma_f32_16x16x32_bf16 v[176:179], v[232:235], v[96:99], v[176:179]
    v_mfma_f32_16x16x32_bf16 v[180:183], v[232:235], v[100:103], v[180:183]
    ds_read_b128 v[228:231], v11 offset:11264
    s_waitcnt lgkmcnt(8)
    v_mfma_f32_16x16x32_bf16 v[184:187], v[236:239], v[96:99], v[184:187]
    v_mfma_f32_16x16x32_bf16 v[188:191], v[236:239], v[100:103], v[188:191]
    ds_read_b128 v[232:235], v11 offset:12288
    s_waitcnt lgkmcnt(8)
    v_mfma_f32_16x16x32_bf16 v[192:195], v[240:243], v[96:99], v[192:195]
    v_mfma_f32_16x16x32_bf16 v[196:199], v[240:243], v[100:103], v[196:199]
    ds_read_b128 v[236:239], v11 offset:13312
    s_waitcnt lgkmcnt(8)
    v_mfma_f32_16x16x32_bf16 v[200:203], v[244:247], v[96:99], v[200:203]
    v_mfma_f32_16x16x32_bf16 v[204:207], v[244:247], v[100:103], v[204:207]
    ds_read_b128 v[240:243], v11 offset:14336
    s_waitcnt lgkmcnt(8)
    v_mfma_f32_16x16x32_bf16 v[208:211], v[248:251], v[96:99], v[208:211]
    v_mfma_f32_16x16x32_bf16 v[212:215], v[248:251], v[100:103], v[212:215]
    buffer_load_dwordx4 a[192:195], v9, s[24:27], s65 offen offset:0
    ds_read_b128 v[244:247], v11 offset:15360
    s_waitcnt vmcnt(27) lgkmcnt(8)
    v_mfma_f32_16x16x32_bf16 v[160:163], v[252:255], v[104:107], v[160:163]
    v_mfma_f32_16x16x32_bf16 v[164:167], v[252:255], v[108:111], v[164:167]
    ds_read_b128 v[248:251], v11 offset:16384
    s_waitcnt lgkmcnt(8)
    v_mfma_f32_16x16x32_bf16 v[168:171], v[216:219], v[104:107], v[168:171]
    v_mfma_f32_16x16x32_bf16 v[172:175], v[216:219], v[108:111], v[172:175]
    ds_read_b128 v[252:255], v11 offset:17408
    s_waitcnt lgkmcnt(8)
    v_mfma_f32_16x16x32_bf16 v[176:179], v[220:223], v[104:107], v[176:179]
    v_mfma_f32_16x16x32_bf16 v[180:183], v[220:223], v[108:111], v[180:183]
    ds_read_b128 v[216:219], v11 offset:18432
    s_waitcnt lgkmcnt(8)
    v_mfma_f32_16x16x32_bf16 v[184:187], v[224:227], v[104:107], v[184:187]
    v_mfma_f32_16x16x32_bf16 v[188:191], v[224:227], v[108:111], v[188:191]
    ds_read_b128 v[220:223], v11 offset:19456
    s_waitcnt lgkmcnt(8)
    v_mfma_f32_16x16x32_bf16 v[192:195], v[228:231], v[104:107], v[192:195]
    v_mfma_f32_16x16x32_bf16 v[196:199], v[228:231], v[108:111], v[196:199]
    ds_read_b128 v[224:227], v11 offset:20480
    s_waitcnt lgkmcnt(8)
    v_mfma_f32_16x16x32_bf16 v[200:203], v[232:235], v[104:107], v[200:203]
    v_mfma_f32_16x16x32_bf16 v[204:207], v[232:235], v[108:111], v[204:207]
    ds_read_b128 v[228:231], v11 offset:21504
    s_waitcnt lgkmcnt(8)
    v_mfma_f32_16x16x32_bf16 v[208:211], v[236:239], v[104:107], v[208:211]
    v_mfma_f32_16x16x32_bf16 v[212:215], v[236:239], v[108:111], v[212:215]
    buffer_load_dwordx4 a[196:199], v9, s[24:27], s65 offen offset:1024
    buffer_load_dwordx4 a[200:203], v9, s[24:27], s65 offen offset:2048
    ds_read_b128 v[232:235], v11 offset:22528
    s_waitcnt vmcnt(25) lgkmcnt(8)
    v_mfma_f32_16x16x32_bf16 v[160:163], v[240:243], v[112:115], v[160:163]
    v_mfma_f32_16x16x32_bf16 v[164:167], v[240:243], v[116:119], v[164:167]
    ds_read_b128 v[236:239], v11 offset:23552
    s_waitcnt lgkmcnt(8)
    v_mfma_f32_16x16x32_bf16 v[168:171], v[244:247], v[112:115], v[168:171]
    v_mfma_f32_16x16x32_bf16 v[172:175], v[244:247], v[116:119], v[172:175]
    ds_read_b128 v[240:243], v11 offset:24576
    s_waitcnt lgkmcnt(8)
    v_mfma_f32_16x16x32_bf16 v[176:179], v[248:251], v[112:115], v[176:179]
    v_mfma_f32_16x16x32_bf16 v[180:183], v[248:251], v[116:119], v[180:183]
    ds_read_b128 v[244:247], v11 offset:25600
    s_waitcnt lgkmcnt(8)
    v_mfma_f32_16x16x32_bf16 v[184:187], v[252:255], v[112:115], v[184:187]
    v_mfma_f32_16x16x32_bf16 v[188:191], v[252:255], v[116:119], v[188:191]
    ds_read_b128 v[248:251], v11 offset:26624
    s_waitcnt lgkmcnt(8)
    v_mfma_f32_16x16x32_bf16 v[192:195], v[216:219], v[112:115], v[192:195]
    v_mfma_f32_16x16x32_bf16 v[196:199], v[216:219], v[116:119], v[196:199]
    ds_read_b128 v[252:255], v11 offset:27648
    s_waitcnt lgkmcnt(8)
    v_mfma_f32_16x16x32_bf16 v[200:203], v[220:223], v[112:115], v[200:203]
    v_mfma_f32_16x16x32_bf16 v[204:207], v[220:223], v[116:119], v[204:207]
    s_waitcnt lgkmcnt(7)
    v_mfma_f32_16x16x32_bf16 v[208:211], v[224:227], v[112:115], v[208:211]
    v_mfma_f32_16x16x32_bf16 v[212:215], v[224:227], v[116:119], v[212:215]
    buffer_load_dwordx4 a[204:207], v9, s[24:27], s65 offen offset:3072
    s_add_u32 s65, s65, 4096
    s_waitcnt vmcnt(23) lgkmcnt(6)
    v_mfma_f32_16x16x32_bf16 v[160:163], v[228:231], v[120:123], v[160:163]
    v_mfma_f32_16x16x32_bf16 v[164:167], v[228:231], v[124:127], v[164:167]
    s_waitcnt lgkmcnt(5)
    v_mfma_f32_16x16x32_bf16 v[168:171], v[232:235], v[120:123], v[168:171]
    v_mfma_f32_16x16x32_bf16 v[172:175], v[232:235], v[124:127], v[172:175]
    s_waitcnt lgkmcnt(4)
    v_mfma_f32_16x16x32_bf16 v[176:179], v[236:239], v[120:123], v[176:179]
    v_mfma_f32_16x16x32_bf16 v[180:183], v[236:239], v[124:127], v[180:183]
    s_waitcnt lgkmcnt(3)
    v_mfma_f32_16x16x32_bf16 v[184:187], v[240:243], v[120:123], v[184:187]
    v_mfma_f32_16x16x32_bf16 v[188:191], v[240:243], v[124:127], v[188:191]
    s_waitcnt lgkmcnt(2)
    v_mfma_f32_16x16x32_bf16 v[192:195], v[244:247], v[120:123], v[192:195]
    v_mfma_f32_16x16x32_bf16 v[196:199], v[244:247], v[124:127], v[196:199]
    s_waitcnt lgkmcnt(1)
    v_mfma_f32_16x16x32_bf16 v[200:203], v[248:251], v[120:123], v[200:203]
    v_mfma_f32_16x16x32_bf16 v[204:207], v[248:251], v[124:127], v[204:207]
    s_waitcnt lgkmcnt(0)
    v_mfma_f32_16x16x32_bf16 v[208:211], v[252:255], v[120:123], v[208:211]
    v_mfma_f32_16x16x32_bf16 v[212:215], v[252:255], v[124:127], v[212:215]
    buffer_load_dwordx4 a[208:211], v9, s[24:27], s65 offen offset:0
    buffer_load_dwordx4 a[212:215], v9, s[24:27], s65 offen offset:1024
    s_branch F_kloop_done
F_kloop1:
    s_nop 7
    s_nop 7
    ds_read_b128 v[216:219], v9 offset:0
    ds_read_b128 v[220:223], v9 offset:1024
    ds_read_b128 v[224:227], v9 offset:2048
    ds_read_b128 v[228:231], v9 offset:3072
    ds_read_b128 v[232:235], v9 offset:4096
    ds_read_b128 v[236:239], v9 offset:5120
    ds_read_b128 v[240:243], v9 offset:6144
    ds_read_b128 v[244:247], v9 offset:7168
    ds_read_b128 v[248:251], v9 offset:8192
    s_waitcnt vmcnt(22) lgkmcnt(8)
    v_mfma_f32_16x16x32_bf16 v[160:163], v[216:219], v[64:67], 0
    v_mfma_f32_16x16x32_bf16 v[164:167], v[216:219], v[68:71], 0
    ds_read_b128 v[252:255], v9 offset:9216
    s_waitcnt lgkmcnt(8)
    v_mfma_f32_16x16x32_bf16 v[168:171], v[220:223], v[64:67], 0
    v_mfma_f32_16x16x32_bf16 v[172:175], v[220:223], v[68:71], 0
    ds_read_b128 v[216:219], v9 offset:10240
    s_waitcnt lgkmcnt(8)
    v_mfma_f32_16x16x32_bf16 v[176:179], v[224:227], v[64:67], 0
    v_mfma_f32_16x16x32_bf16 v[180:183], v[224:227], v[68:71], 0
    ds_read_b128 v[220:223], v9 offset:11264
    s_waitcnt lgkmcnt(8)
    v_mfma_f32_16x16x32_bf16 v[184:187], v[228:231], v[64:67], 0
    v_mfma_f32_16x16x32_bf16 v[188:191], v[228:231], v[68:71], 0
    ds_read_b128 v[224:227], v9 offset:12288
    s_waitcnt lgkmcnt(8)
    v_mfma_f32_16x16x32_bf16 v[192:195], v[232:235], v[64:67], 0
    v_mfma_f32_16x16x32_bf16 v[196:199], v[232:235], v[68:71], 0
    ds_read_b128 v[228:231], v9 offset:13312
    s_waitcnt lgkmcnt(8)
    v_mfma_f32_16x16x32_bf16 v[200:203], v[236:239], v[64:67], 0
    v_mfma_f32_16x16x32_bf16 v[204:207], v[236:239], v[68:71], 0
    ds_read_b128 v[232:235], v9 offset:14336
    s_waitcnt lgkmcnt(8)
    v_mfma_f32_16x16x32_bf16 v[208:211], v[240:243], v[64:67], 0
    v_mfma_f32_16x16x32_bf16 v[212:215], v[240:243], v[68:71], 0
    buffer_load_dwordx4 v[64:67], v9, s[24:27], s62 offen offset:0 sc1 nt
    buffer_load_dwordx4 v[68:71], v9, s[24:27], s63 offen offset:0 sc1 nt
    ds_read_b128 v[236:239], v9 offset:15360
    s_waitcnt vmcnt(22) lgkmcnt(8)
    v_mfma_f32_16x16x32_bf16 v[160:163], v[244:247], v[72:75], v[160:163]
    v_mfma_f32_16x16x32_bf16 v[164:167], v[244:247], v[76:79], v[164:167]
    ds_read_b128 v[240:243], v9 offset:16384
    s_waitcnt lgkmcnt(8)
    v_mfma_f32_16x16x32_bf16 v[168:171], v[248:251], v[72:75], v[168:171]
    v_mfma_f32_16x16x32_bf16 v[172:175], v[248:251], v[76:79], v[172:175]
    ds_read_b128 v[244:247], v9 offset:17408
    s_waitcnt lgkmcnt(8)
    v_mfma_f32_16x16x32_bf16 v[176:179], v[252:255], v[72:75], v[176:179]
    v_mfma_f32_16x16x32_bf16 v[180:183], v[252:255], v[76:79], v[180:183]
    ds_read_b128 v[248:251], v9 offset:18432
    s_waitcnt lgkmcnt(8)
    v_mfma_f32_16x16x32_bf16 v[184:187], v[216:219], v[72:75], v[184:187]
    v_mfma_f32_16x16x32_bf16 v[188:191], v[216:219], v[76:79], v[188:191]
    ds_read_b128 v[252:255], v9 offset:19456
    s_waitcnt lgkmcnt(8)
    v_mfma_f32_16x16x32_bf16 v[192:195], v[220:223], v[72:75], v[192:195]
    v_mfma_f32_16x16x32_bf16 v[196:199], v[220:223], v[76:79], v[196:199]
    ds_read_b128 v[216:219], v9 offset:20480
    s_waitcnt lgkmcnt(8)
    v_mfma_f32_16x16x32_bf16 v[200:203], v[224:227], v[72:75], v[200:203]
    v_mfma_f32_16x16x32_bf16 v[204:207], v[224:227], v[76:79], v[204:207]
    ds_read_b128 v[220:223], v9 offset:21504
    s_waitcnt lgkmcnt(8)
    v_mfma_f32_16x16x32_bf16 v[208:211], v[228:231], v[72:75], v[208:211]
    v_mfma_f32_16x16x32_bf16 v[212:215], v[228:231], v[76:79], v[212:215]
    buffer_load_dwordx4 v[72:75], v9, s[24:27], s62 offen offset:1024 sc1 nt
    buffer_load_dwordx4 v[76:79], v9, s[24:27], s63 offen offset:1024 sc1 nt
    ds_read_b128 v[224:227], v9 offset:22528
    s_waitcnt vmcnt(22) lgkmcnt(8)
    v_mfma_f32_16x16x32_bf16 v[160:163], v[232:235], v[80:83], v[160:163]
    v_mfma_f32_16x16x32_bf16 v[164:167], v[232:235], v[84:87], v[164:167]
    ds_read_b128 v[228:231], v9 offset:23552
    s_waitcnt lgkmcnt(8)
    v_mfma_f32_16x16x32_bf16 v[168:171], v[236:239], v[80:83], v[168:171]
    v_mfma_f32_16x16x32_bf16 v[172:175], v[236:239], v[84:87], v[172:175]
    ds_read_b128 v[232:235], v9 offset:24576
    s_waitcnt lgkmcnt(8)
    v_mfma_f32_16x16x32_bf16 v[176:179], v[240:243], v[80:83], v[176:179]
    v_mfma_f32_16x16x32_bf16 v[180:183], v[240:243], v[84:87], v[180:183]
    ds_read_b128 v[236:239], v9 offset:25600
    s_waitcnt lgkmcnt(8)
    v_mfma_f32_16x16x32_bf16 v[184:187], v[244:247], v[80:83], v[184:187]
    v_mfma_f32_16x16x32_bf16 v[188:191], v[244:247], v[84:87], v[188:191]
    ds_read_b128 v[240:243], v9 offset:26624
    s_waitcnt lgkmcnt(8)
    v_mfma_f32_16x16x32_bf16 v[192:195], v[248:251], v[80:83], v[192:195]
    v_mfma_f32_16x16x32_bf16 v[196:199], v[248:251], v[84:87], v[196:199]
    ds_read_b128 v[244:247], v9 offset:27648
    s_waitcnt lgkmcnt(8)
    v_mfma_f32_16x16x32_bf16 v[200:203], v[252:255], v[80:83], v[200:203]
    v_mfma_f32_16x16x32_bf16 v[204:207], v[252:255], v[84:87], v[204:207]
    ds_read_b128 v[248:251], v9 offset:28672
    s_waitcnt lgkmcnt(8)
    v_mfma_f32_16x16x32_bf16 v[208:211], v[216:219], v[80:83], v[208:211]
    v_mfma_f32_16x16x32_bf16 v[212:215], v[216:219], v[84:87], v[212:215]
    buffer_load_dwordx4 v[80:83], v9, s[24:27], s62 offen offset:2048 sc1 nt
    buffer_load_dwordx4 v[84:87], v9, s[24:27], s63 offen offset:2048 sc1 nt
    ds_read_b128 v[252:255], v9 offset:29696
    s_waitcnt vmcnt(22) lgkmcnt(8)
    v_mfma_f32_16x16x32_bf16 v[160:163], v[220:223], v[88:91], v[160:163]
    v_mfma_f32_16x16x32_bf16 v[164:167], v[220:223], v[92:95], v[164:167]
    ds_read_b128 v[216:219], v9 offset:30720
    s_waitcnt lgkmcnt(8)
    v_mfma_f32_16x16x32_bf16 v[168:171], v[224:227], v[88:91], v[168:171]
    v_mfma_f32_16x16x32_bf16 v[172:175], v[224:227], v[92:95], v[172:175]
    ds_read_b128 v[220:223], v9 offset:31744
    s_waitcnt lgkmcnt(8)
    v_mfma_f32_16x16x32_bf16 v[176:179], v[228:231], v[88:91], v[176:179]
    v_mfma_f32_16x16x32_bf16 v[180:183], v[228:231], v[92:95], v[180:183]
    ds_read_b128 v[224:227], v9 offset:32768
    s_waitcnt lgkmcnt(8)
    v_mfma_f32_16x16x32_bf16 v[184:187], v[232:235], v[88:91], v[184:187]
    v_mfma_f32_16x16x32_bf16 v[188:191], v[232:235], v[92:95], v[188:191]
    ds_read_b128 v[228:231], v9 offset:33792
    s_waitcnt lgkmcnt(8)
    v_mfma_f32_16x16x32_bf16 v[192:195], v[236:239], v[88:91], v[192:195]
    v_mfma_f32_16x16x32_bf16 v[196:199], v[236:239], v[92:95], v[196:199]
    ds_read_b128 v[232:235], v9 offset:34816
    s_waitcnt lgkmcnt(8)
    v_mfma_f32_16x16x32_bf16 v[200:203], v[240:243], v[88:91], v[200:203]
    v_mfma_f32_16x16x32_bf16 v[204:207], v[240:243], v[92:95], v[204:207]
    ds_read_b128 v[236:239], v9 offset:35840
    s_waitcnt lgkmcnt(8)
    v_mfma_f32_16x16x32_bf16 v[208:211], v[244:247], v[88:91], v[208:211]
    v_mfma_f32_16x16x32_bf16 v[212:215], v[244:247], v[92:95], v[212:215]
    buffer_load_dwordx4 v[88:91], v9, s[24:27], s62 offen offset:3072 sc1 nt
    buffer_load_dwordx4 v[92:95], v9, s[24:27], s63 offen offset:3072 sc1 nt
    s_add_u32 s62, s62, 4096
    s_add_u32 s63, s63, 4096
    ds_read_b128 v[240:243], v9 offset:36864
    s_waitcnt vmcnt(22) lgkmcnt(8)
    v_mfma_f32_16x16x32_bf16 v[160:163], v[248:251], v[96:99], v[160:163]
    v_mfma_f32_16x16x32_bf16 v[164:167], v[248:251], v[100:103], v[164:167]
    ds_read_b128 v[244:247], v9 offset:37888
    s_waitcnt lgkmcnt(8)
    v_mfma_f32_16x16x32_bf16 v[168:171], v[252:255], v[96:99], v[168:171]
    v_mfma_f32_16x16x32_bf16 v[172:175], v[252:255], v[100:103], v[172:175]
    ds_read_b128 v[248:251], v9 offset:38912
    s_waitcnt lgkmcnt(8)
    v_mfma_f32_16x16x32_bf16 v[176:179], v[216:219], v[96:99], v[176:179]
    v_mfma_f32_16x16x32_bf16 v[180:183], v[216:219], v[100:103], v[180:183]
    ds_read_b128 v[252:255], v9 offset:39936
    s_waitcnt lgkmcnt(8)
    v_mfma_f32_16x16x32_bf16 v[184:187], v[220:223], v[96:99], v[184:187]
    v_mfma_f32_16x16x32_bf16 v[188:191], v[220:223], v[100:103], v[188:191]
    ds_read_b128 v[216:219], v9 offset:40960
    s_waitcnt lgkmcnt(8)
    v_mfma_f32_16x16x32_bf16 v[192:195], v[224:227], v[96:99], v[192:195]
    v_mfma_f32_16x16x32_bf16 v[196:199], v[224:227], v[100:103], v[196:199]
    ds_read_b128 v[220:223], v9 offset:41984
    s_waitcnt lgkmcnt(8)
    v_mfma_f32_16x16x32_bf16 v[200:203], v[228:231], v[96:99], v[200:203]
    v_mfma_f32_16x16x32_bf16 v[204:207], v[228:231], v[100:103], v[204:207]
    ds_read_b128 v[224:227], v9 offset:43008
    s_waitcnt lgkmcnt(8)
    v_mfma_f32_16x16x32_bf16 v[208:211], v[232:235], v[96:99], v[208:211]
    v_mfma_f32_16x16x32_bf16 v[212:215], v[232:235], v[100:103], v[212:215]
    buffer_load_dwordx4 v[96:99], v9, s[24:27], s62 offen offset:0 sc1 nt
    buffer_load_dwordx4 v[100:103], v9, s[24:27], s63 offen offset:0 sc1 nt
    ds_read_b128 v[228:231], v9 offset:44032
    s_waitcnt vmcnt(22) lgkmcnt(8)
    v_mfma_f32_16x16x32_bf16 v[160:163], v[236:239], v[104:107], v[160:163]
    v_mfma_f32_16x16x32_bf16 v[164:167], v[236:239], v[108:111], v[164:167]
    ds_read_b128 v[232:235], v9 offset:45056
    s_waitcnt lgkmcnt(8)
    v_mfma_f32_16x16x32_bf16 v[168:171], v[240:243], v[104:107], v[168:171]
    v_mfma_f32_16x16x32_bf16 v[172:175], v[240:243], v[108:111], v[172:175]
    ds_read_b128 v[236:239], v9 offset:46080
    s_waitcnt lgkmcnt(8)
    v_mfma_f32_16x16x32_bf16 v[176:179], v[244:247], v[104:107], v[176:179]
    v_mfma_f32_16x16x32_bf16 v[180:183], v[244:247], v[108:111], v[180:183]
    ds_read_b128 v[240:243], v9 offset:47104
    s_waitcnt lgkmcnt(8)
    v_mfma_f32_16x16x32_bf16 v[184:187], v[248:251], v[104:107], v[184:187]
    v_mfma_f32_16x16x32_bf16 v[188:191], v[248:251], v[108:111], v[188:191]
    ds_read_b128 v[244:247], v9 offset:48128
    s_waitcnt lgkmcnt(8)
    v_mfma_f32_16x16x32_bf16 v[192:195], v[252:255], v[104:107], v[192:195]
    v_mfma_f32_16x16x32_bf16 v[196:199], v[252:255], v[108:111], v[196:199]
    ds_read_b128 v[248:251], v9 offset:49152
    s_waitcnt lgkmcnt(8)
    v_mfma_f32_16x16x32_bf16 v[200:203], v[216:219], v[104:107], v[200:203]
    v_mfma_f32_16x16x32_bf16 v[204:207], v[216:219], v[108:111], v[204:207]
    ds_read_b128 v[252:255], v9 offset:50176
    s_waitcnt lgkmcnt(8)
    v_mfma_f32_16x16x32_bf16 v[208:211], v[220:223], v[104:107], v[208:211]
    v_mfma_f32_16x16x32_bf16 v[212:215], v[220:223], v[108:111], v[212:215]
    buffer_load_dwordx4 v[104:107], v9, s[24:27], s62 offen offset:1024 sc1 nt
    buffer_load_dwordx4 v[108:111], v9, s[24:27], s63 offen offset:1024 sc1 nt
    ds_read_b128 v[216:219], v9 offset:51200
    s_waitcnt vmcnt(22) lgkmcnt(8)
    v_mfma_f32_16x16x32_bf16 v[160:163], v[224:227], v[112:115], v[160:163]
    v_mfma_f32_16x16x32_bf16 v[164:167], v[224:227], v[116:119], v[164:167]
    ds_read_b128 v[220:223], v9 offset:52224
    s_waitcnt lgkmcnt(8)
    v_mfma_f32_16x16x32_bf16 v[168:171], v[228:231], v[112:115], v[168:171]
    v_mfma_f32_16x16x32_bf16 v[172:175], v[228:231], v[116:119], v[172:175]
    ds_read_b128 v[224:227], v9 offset:53248
    s_waitcnt lgkmcnt(8)
    v_mfma_f32_16x16x32_bf16 v[176:179], v[232:235], v[112:115], v[176:179]
    v_mfma_f32_16x16x32_bf16 v[180:183], v[232:235], v[116:119], v[180:183]
    ds_read_b128 v[228:231], v9 offset:54272
    s_waitcnt lgkmcnt(8)
    v_mfma_f32_16x16x32_bf16 v[184:187], v[236:239], v[112:115], v[184:187]
    v_mfma_f32_16x16x32_bf16 v[188:191], v[236:239], v[116:119], v[188:191]
    ds_read_b128 v[232:235], v9 offset:55296
    s_waitcnt lgkmcnt(8)
    v_mfma_f32_16x16x32_bf16 v[192:195], v[240:243], v[112:115], v[192:195]
    v_mfma_f32_16x16x32_bf16 v[196:199], v[240:243], v[116:119], v[196:199]
    ds_read_b128 v[236:239], v9 offset:56320
    s_waitcnt lgkmcnt(8)
    v_mfma_f32_16x16x32_bf16 v[200:203], v[244:247], v[112:115], v[200:203]
    v_mfma_f32_16x16x32_bf16 v[204:207], v[244:247], v[116:119], v[204:207]
    ds_read_b128 v[240:243], v10 offset:0
    s_waitcnt lgkmcnt(8)
    v_mfma_f32_16x16x32_bf16 v[208:211], v[248:251], v[112:115], v[208:211]
    v_mfma_f32_16x16x32_bf16 v[212:215], v[248:251], v[116:119], v[212:215]
    buffer_load_dwordx4 v[112:115], v9, s[24:27], s62 offen offset:2048 sc1 nt
    buffer_load_dwordx4 v[116:119], v9, s[24:27], s63 offen offset:2048 sc1 nt
    ds_read_b128 v[244:247], v10 offset:1024
    s_waitcnt vmcnt(22) lgkmcnt(8)
    v_mfma_f32_16x16x32_bf16 v[160:163], v[252:255], v[120:123], v[160:163]
    v_mfma_f32_16x16x32_bf16 v[164:167], v[252:255], v[124:127], v[164:167]
    ds_read_b128 v[248:251], v10 offset:2048
    s_waitcnt lgkmcnt(8)
    v_mfma_f32_16x16x32_bf16 v[168:171], v[216:219], v[120:123], v[168:171]
    v_mfma_f32_16x16x32_bf16 v[172:175], v[216:219], v[124:127], v[172:175]
    ds_read_b128 v[252:255], v10 offset:3072
    s_waitcnt lgkmcnt(8)
    v_mfma_f32_16x16x32_bf16 v[176:179], v[220:223], v[120:123], v[176:179]
    v_mfma_f32_16x16x32_bf16 v[180:183], v[220:223], v[124:127], v[180:183]
    ds_read_b128 v[216:219], v10 offset:4096
    s_waitcnt lgkmcnt(8)
    v_mfma_f32_16x16x32_bf16 v[184:187], v[224:227], v[120:123], v[184:187]
    v_mfma_f32_16x16x32_bf16 v[188:191], v[224:227], v[124:127], v[188:191]
    ds_read_b128 v[220:223], v10 offset:5120
    s_waitcnt lgkmcnt(8)
    v_mfma_f32_16x16x32_bf16 v[192:195], v[228:231], v[120:123], v[192:195]
    v_mfma_f32_16x16x32_bf16 v[196:199], v[228:231], v[124:127], v[196:199]
    ds_read_b128 v[224:227], v10 offset:6144
    s_waitcnt lgkmcnt(8)
    v_mfma_f32_16x16x32_bf16 v[200:203], v[232:235], v[120:123], v[200:203]
    v_mfma_f32_16x16x32_bf16 v[204:207], v[232:235], v[124:127], v[204:207]
    ds_read_b128 v[228:231], v10 offset:7168
    s_waitcnt lgkmcnt(8)
    v_mfma_f32_16x16x32_bf16 v[208:211], v[236:239], v[120:123], v[208:211]
    v_mfma_f32_16x16x32_bf16 v[212:215], v[236:239], v[124:127], v[212:215]
    buffer_load_dwordx4 v[120:123], v9, s[24:27], s62 offen offset:3072 sc1 nt
    buffer_load_dwordx4 v[124:127], v9, s[24:27], s63 offen offset:3072 sc1 nt
    s_add_u32 s62, s62, 4096
    s_add_u32 s63, s63, 4096
    ds_read_b128 v[232:235], v10 offset:8192
    s_waitcnt vmcnt(22) lgkmcnt(8)
    v_mfma_f32_16x16x32_bf16 v[160:163], v[240:243], v[128:131], v[160:163]
    v_mfma_f32_16x16x32_bf16 v[164:167], v[240:243], v[132:135], v[164:167]
    ds_read_b128 v[236:239], v10 offset:9216
    s_waitcnt lgkmcnt(8)
    v_mfma_f32_16x16x32_bf16 v[168:171], v[244:247], v[128:131], v[168:171]
    v_mfma_f32_16x16x32_bf16 v[172:175], v[244:247], v[132:135], v[172:175]
    ds_read_b128 v[240:243], v10 offset:10240
    s_waitcnt lgkmcnt(8)
    v_mfma_f32_16x16x32_bf16 v[176:179], v[248:251], v[128:131], v[176:179]
    v_mfma_f32_16x16x32_bf16 v[180:183], v[248:251], v[132:135], v[180:183]
    ds_read_b128 v[244:247], v10 offset:11264
    s_waitcnt lgkmcnt(8)
    v_mfma_f32_16x16x32_bf16 v[184:187], v[252:255], v[128:131], v[184:187]
    v_mfma_f32_16x16x32_bf16 v[188:191], v[252:255], v[132:135], v[188:191]
    ds_read_b128 v[248:251], v10 offset:12288
    s_waitcnt lgkmcnt(8)
    v_mfma_f32_16x16x32_bf16 v[192:195], v[216:219], v[128:131], v[192:195]
    v_mfma_f32_16x16x32_bf16 v[196:199], v[216:219], v[132:135], v[196:199]
    ds_read_b128 v[252:255], v10 offset:13312
    s_waitcnt lgkmcnt(8)
    v_mfma_f32_16x16x32_bf16 v[200:203], v[220:223], v[128:131], v[200:203]
    v_mfma_f32_16x16x32_bf16 v[204:207], v[220:223], v[132:135], v[204:207]
    ds_read_b128 v[216:219], v10 offset:14336
    s_waitcnt lgkmcnt(8)
    v_mfma_f32_16x16x32_bf16 v[208:211], v[224:227], v[128:131], v[208:211]
    v_mfma_f32_16x16x32_bf16 v[212:215], v[224:227], v[132:135], v[212:215]
    ds_read_b128 v[220:223], v10 offset:15360
    s_waitcnt vmcnt(20) lgkmcnt(8)
    v_mfma_f32_16x16x32_bf16 v[160:163], v[228:231], v[136:139], v[160:163]
    v_mfma_f32_16x16x32_bf16 v[164:167], v[228:231], v[140:143], v[164:167]
    ds_read_b128 v[224:227], v10 offset:16384
    s_waitcnt lgkmcnt(8)
    v_mfma_f32_16x16x32_bf16 v[168:171], v[232:235], v[136:139], v[168:171]
    v_mfma_f32_16x16x32_bf16 v[172:175], v[232:235], v[140:143], v[172:175]
    ds_read_b128 v[228:231], v10 offset:17408
    s_waitcnt lgkmcnt(8)
    v_mfma_f32_16x16x32_bf16 v[176:179], v[236:239], v[136:139], v[176:179]
    v_mfma_f32_16x16x32_bf16 v[180:183], v[236:239], v[140:143], v[180:183]
    ds_read_b128 v[232:235], v10 offset:18432
    s_waitcnt lgkmcnt(8)
    v_mfma_f32_16x16x32_bf16 v[184:187], v[240:243], v[136:139], v[184:187]
    v_mfma_f32_16x16x32_bf16 v[188:191], v[240:243], v[140:143], v[188:191]
    ds_read_b128 v[236:239], v10 offset:19456
    s_waitcnt lgkmcnt(8)
    v_mfma_f32_16x16x32_bf16 v[192:195], v[244:247], v[136:139], v[192:195]
    v_mfma_f32_16x16x32_bf16 v[196:199], v[244:247], v[140:143], v[196:199]
    ds_read_b128 v[240:243], v10 offset:20480
    s_waitcnt lgkmcnt(8)
    v_mfma_f32_16x16x32_bf16 v[200:203], v[248:251], v[136:139], v[200:203]
    v_mfma_f32_16x16x32_bf16 v[204:207], v[248:251], v[140:143], v[204:207]
    ds_read_b128 v[244:247], v10 offset:21504
    s_waitcnt lgkmcnt(8)
    v_mfma_f32_16x16x32_bf16 v[208:211], v[252:255], v[136:139], v[208:211]
    v_mfma_f32_16x16x32_bf16 v[212:215], v[252:255], v[140:143], v[212:215]
    buffer_load_dwordx2 v[16:17], v14, s[24:27], s45 offen offset:0 sc1 nt
    buffer_load_dwordx2 v[18:19], v14, s[24:27], s45 offen offset:32 sc1 nt
    buffer_load_dwordx2 v[20:21], v14, s[24:27], s45 offen offset:64 sc1 nt
    buffer_load_dwordx2 v[22:23], v14, s[24:27], s45 offen offset:96 sc1 nt
    buffer_load_dwordx2 v[24:25], v14, s[24:27], s45 offen offset:128 sc1 nt
    ds_read_b128 v[248:251], v10 offset:22528
    s_waitcnt vmcnt(23) lgkmcnt(8)
    v_mfma_f32_16x16x32_bf16 v[160:163], v[216:219], v[144:147], v[160:163]
    v_mfma_f32_16x16x32_bf16 v[164:167], v[216:219], v[148:151], v[164:167]
    ds_read_b128 v[252:255], v10 offset:23552
    s_waitcnt lgkmcnt(8)
    v_mfma_f32_16x16x32_bf16 v[168:171], v[220:223], v[144:147], v[168:171]
    v_mfma_f32_16x16x32_bf16 v[172:175], v[220:223], v[148:151], v[172:175]
    ds_read_b128 v[216:219], v10 offset:24576
    s_waitcnt lgkmcnt(8)
    v_mfma_f32_16x16x32_bf16 v[176:179], v[224:227], v[144:147], v[176:179]
    v_mfma_f32_16x16x32_bf16 v[180:183], v[224:227], v[148:151], v[180:183]
    ds_read_b128 v[220:223], v10 offset:25600
    s_waitcnt lgkmcnt(8)
    v_mfma_f32_16x16x32_bf16 v[184:187], v[228:231], v[144:147], v[184:187]
    v_mfma_f32_16x16x32_bf16 v[188:191], v[228:231], v[148:151], v[188:191]
    ds_read_b128 v[224:227], v10 offset:26624
    s_waitcnt lgkmcnt(8)
    v_mfma_f32_16x16x32_bf16 v[192:195], v[232:235], v[144:147], v[192:195]
    v_mfma_f32_16x16x32_bf16 v[196:199], v[232:235], v[148:151], v[196:199]
    ds_read_b128 v[228:231], v10 offset:27648
    s_waitcnt lgkmcnt(8)
    v_mfma_f32_16x16x32_bf16 v[200:203], v[236:239], v[144:147], v[200:203]
    v_mfma_f32_16x16x32_bf16 v[204:207], v[236:239], v[148:151], v[204:207]
    ds_read_b128 v[232:235], v10 offset:28672
    s_waitcnt lgkmcnt(8)
    v_mfma_f32_16x16x32_bf16 v[208:211], v[240:243], v[144:147], v[208:211]
    v_mfma_f32_16x16x32_bf16 v[212:215], v[240:243], v[148:151], v[212:215]
    ds_read_b128 v[236:239], v10 offset:29696
    s_waitcnt vmcnt(21) lgkmcnt(8)
    v_mfma_f32_16x16x32_bf16 v[160:163], v[244:247], v[152:155], v[160:163]
    v_mfma_f32_16x16x32_bf16 v[164:167], v[244:247], v[156:159], v[164:167]
    ds_read_b128 v[240:243], v10 offset:30720
    s_waitcnt lgkmcnt(8)
    v_mfma_f32_16x16x32_bf16 v[168:171], v[248:251], v[152:155], v[168:171]
    v_mfma_f32_16x16x32_bf16 v[172:175], v[248:251], v[156:159], v[172:175]
    ds_read_b128 v[244:247], v10 offset:31744
    s_waitcnt lgkmcnt(8)
    v_mfma_f32_16x16x32_bf16 v[176:179], v[252:255], v[152:155], v[176:179]
    v_mfma_f32_16x16x32_bf16 v[180:183], v[252:255], v[156:159], v[180:183]
    ds_read_b128 v[248:251], v10 offset:32768
    s_waitcnt lgkmcnt(8)
    v_mfma_f32_16x16x32_bf16 v[184:187], v[216:219], v[152:155], v[184:187]
    v_mfma_f32_16x16x32_bf16 v[188:191], v[216:219], v[156:159], v[188:191]
    ds_read_b128 v[252:255], v10 offset:33792
    s_waitcnt lgkmcnt(8)
    v_mfma_f32_16x16x32_bf16 v[192:195], v[220:223], v[152:155], v[192:195]
    v_mfma_f32_16x16x32_bf16 v[196:199], v[220:223], v[156:159], v[196:199]
    ds_read_b128 v[216:219], v10 offset:34816
    s_waitcnt lgkmcnt(8)
    v_mfma_f32_16x16x32_bf16 v[200:203], v[224:227], v[152:155], v[200:203]
    v_mfma_f32_16x16x32_bf16 v[204:207], v[224:227], v[156:159], v[204:207]
    ds_read_b128 v[220:223], v10 offset:35840
    s_waitcnt lgkmcnt(8)
    v_mfma_f32_16x16x32_bf16 v[208:211], v[228:231], v[152:155], v[208:211]
    v_mfma_f32_16x16x32_bf16 v[212:215], v[228:231], v[156:159], v[212:215]
    ds_read_b128 v[224:227], v10 offset:36864
    s_waitcnt vmcnt(19) lgkmcnt(8)
    v_mfma_f32_16x16x32_bf16 v[160:163], v[232:235], v[64:67], v[160:163]
    v_mfma_f32_16x16x32_bf16 v[164:167], v[232:235], v[68:71], v[164:167]
    ds_read_b128 v[228:231], v10 offset:37888
    s_waitcnt lgkmcnt(8)
    v_mfma_f32_16x16x32_bf16 v[168:171], v[236:239], v[64:67], v[168:171]
    v_mfma_f32_16x16x32_bf16 v[172:175], v[236:239], v[68:71], v[172:175]
    ds_read_b128 v[232:235], v10 offset:38912
    s_waitcnt lgkmcnt(8)
    v_mfma_f32_16x16x32_bf16 v[176:179], v[240:243], v[64:67], v[176:179]
    v_mfma_f32_16x16x32_bf16 v[180:183], v[240:243], v[68:71], v[180:183]
    ds_read_b128 v[236:239], v10 offset:39936
    s_waitcnt lgkmcnt(8)
    v_mfma_f32_16x16x32_bf16 v[184:187], v[244:247], v[64:67], v[184:187]
    v_mfma_f32_16x16x32_bf16 v[188:191], v[244:247], v[68:71], v[188:191]
    ds_read_b128 v[240:243], v10 offset:40960
    s_waitcnt lgkmcnt(8)
    v_mfma_f32_16x16x32_bf16 v[192:195], v[248:251], v[64:67], v[192:195]
    v_mfma_f32_16x16x32_bf16 v[196:199], v[248:251], v[68:71], v[196:199]
    ds_read_b128 v[244:247], v10 offset:41984
    s_waitcnt lgkmcnt(8)
    v_mfma_f32_16x16x32_bf16 v[200:203], v[252:255], v[64:67], v[200:203]
    v_mfma_f32_16x16x32_bf16 v[204:207], v[252:255], v[68:71], v[204:207]
    ds_read_b128 v[248:251], v10 offset:43008
    s_waitcnt lgkmcnt(8)
    v_mfma_f32_16x16x32_bf16 v[208:211], v[216:219], v[64:67], v[208:211]
    v_mfma_f32_16x16x32_bf16 v[212:215], v[216:219], v[68:71], v[212:215]
    ds_read_b128 v[252:255], v10 offset:44032
    s_waitcnt vmcnt(17) lgkmcnt(8)
    v_mfma_f32_16x16x32_bf16 v[160:163], v[220:223], v[72:75], v[160:163]
    v_mfma_f32_16x16x32_bf16 v[164:167], v[220:223], v[76:79], v[164:167]
    ds_read_b128 v[216:219], v10 offset:45056
    s_waitcnt lgkmcnt(8)
    v_mfma_f32_16x16x32_bf16 v[168:171], v[224:227], v[72:75], v[168:171]
    v_mfma_f32_16x16x32_bf16 v[172:175], v[224:227], v[76:79], v[172:175]
    ds_read_b128 v[220:223], v10 offset:46080
    s_waitcnt lgkmcnt(8)
    v_mfma_f32_16x16x32_bf16 v[176:179], v[228:231], v[72:75], v[176:179]
    v_mfma_f32_16x16x32_bf16 v[180:183], v[228:231], v[76:79], v[180:183]
    ds_read_b128 v[224:227], v10 offset:47104
    s_waitcnt lgkmcnt(8)
    v_mfma_f32_16x16x32_bf16 v[184:187], v[232:235], v[72:75], v[184:187]
    v_mfma_f32_16x16x32_bf16 v[188:191], v[232:235], v[76:79], v[188:191]
    ds_read_b128 v[228:231], v10 offset:48128
    s_waitcnt lgkmcnt(8)
    v_mfma_f32_16x16x32_bf16 v[192:195], v[236:239], v[72:75], v[192:195]
    v_mfma_f32_16x16x32_bf16 v[196:199], v[236:239], v[76:79], v[196:199]
    ds_read_b128 v[232:235], v10 offset:49152
    s_waitcnt lgkmcnt(8)
    v_mfma_f32_16x16x32_bf16 v[200:203], v[240:243], v[72:75], v[200:203]
    v_mfma_f32_16x16x32_bf16 v[204:207], v[240:243], v[76:79], v[204:207]
    ds_read_b128 v[236:239], v10 offset:50176
    s_waitcnt lgkmcnt(8)
    v_mfma_f32_16x16x32_bf16 v[208:211], v[244:247], v[72:75], v[208:211]
    v_mfma_f32_16x16x32_bf16 v[212:215], v[244:247], v[76:79], v[212:215]
    ds_read_b128 v[240:243], v10 offset:51200
    s_waitcnt vmcnt(15) lgkmcnt(8)
    v_mfma_f32_16x16x32_bf16 v[160:163], v[248:251], v[80:83], v[160:163]
    v_mfma_f32_16x16x32_bf16 v[164:167], v[248:251], v[84:87], v[164:167]
    ds_read_b128 v[244:247], v10 offset:52224
    s_waitcnt lgkmcnt(8)
    v_mfma_f32_16x16x32_bf16 v[168:171], v[252:255], v[80:83], v[168:171]
    v_mfma_f32_16x16x32_bf16 v[172:175], v[252:255], v[84:87], v[172:175]
    ds_read_b128 v[248:251], v10 offset:53248
    s_waitcnt lgkmcnt(8)
    v_mfma_f32_16x16x32_bf16 v[176:179], v[216:219], v[80:83], v[176:179]
    v_mfma_f32_16x16x32_bf16 v[180:183], v[216:219], v[84:87], v[180:183]
    ds_read_b128 v[252:255], v10 offset:54272
    s_waitcnt lgkmcnt(8)
    v_mfma_f32_16x16x32_bf16 v[184:187], v[220:223], v[80:83], v[184:187]
    v_mfma_f32_16x16x32_bf16 v[188:191], v[220:223], v[84:87], v[188:191]
    ds_read_b128 v[216:219], v10 offset:55296
    s_waitcnt lgkmcnt(8)
    v_mfma_f32_16x16x32_bf16 v[192:195], v[224:227], v[80:83], v[192:195]
    v_mfma_f32_16x16x32_bf16 v[196:199], v[224:227], v[84:87], v[196:199]
    ds_read_b128 v[220:223], v10 offset:56320
    s_waitcnt lgkmcnt(8)
    v_mfma_f32_16x16x32_bf16 v[200:203], v[228:231], v[80:83], v[200:203]
    v_mfma_f32_16x16x32_bf16 v[204:207], v[228:231], v[84:87], v[204:207]
    ds_read_b128 v[224:227], v11 offset:0
    s_waitcnt lgkmcnt(8)
    v_mfma_f32_16x16x32_bf16 v[208:211], v[232:235], v[80:83], v[208:211]
    v_mfma_f32_16x16x32_bf16 v[212:215], v[232:235], v[84:87], v[212:215]
    ds_read_b128 v[228:231], v11 offset:1024
    s_waitcnt vmcnt(13) lgkmcnt(8)
    v_mfma_f32_16x16x32_bf16 v[160:163], v[236:239], v[88:91], v[160:163]
    v_mfma_f32_16x16x32_bf16 v[164:167], v[236:239], v[92:95], v[164:167]
    ds_read_b128 v[232:235], v11 offset:2048
    s_waitcnt lgkmcnt(8)
    v_mfma_f32_16x16x32_bf16 v[168:171], v[240:243], v[88:91], v[168:171]
    v_mfma_f32_16x16x32_bf16 v[172:175], v[240:243], v[92:95], v[172:175]
    ds_read_b128 v[236:239], v11 offset:3072
    s_waitcnt lgkmcnt(8)
    v_mfma_f32_16x16x32_bf16 v[176:179], v[244:247], v[88:91], v[176:179]
    v_mfma_f32_16x16x32_bf16 v[180:183], v[244:247], v[92:95], v[180:183]
    ds_read_b128 v[240:243], v11 offset:4096
    s_waitcnt lgkmcnt(8)
    v_mfma_f32_16x16x32_bf16 v[184:187], v[248:251], v[88:91], v[184:187]
    v_mfma_f32_16x16x32_bf16 v[188:191], v[248:251], v[92:95], v[188:191]
    ds_read_b128 v[244:247], v11 offset:5120
    s_waitcnt lgkmcnt(8)
    v_mfma_f32_16x16x32_bf16 v[192:195], v[252:255], v[88:91], v[192:195]
    v_mfma_f32_16x16x32_bf16 v[196:199], v[252:255], v[92:95], v[196:199]
    ds_read_b128 v[248:251], v11 offset:6144
    s_waitcnt lgkmcnt(8)
    v_mfma_f32_16x16x32_bf16 v[200:203], v[216:219], v[88:91], v[200:203]
    v_mfma_f32_16x16x32_bf16 v[204:207], v[216:219], v[92:95], v[204:207]
    ds_read_b128 v[252:255], v11 offset:7168
    s_waitcnt lgkmcnt(8)
    v_mfma_f32_16x16x32_bf16 v[208:211], v[220:223], v[88:91], v[208:211]
    v_mfma_f32_16x16x32_bf16 v[212:215], v[220:223], v[92:95], v[212:215]
    ds_read_b128 v[216:219], v11 offset:8192
    s_waitcnt vmcnt(11) lgkmcnt(8)
    v_mfma_f32_16x16x32_bf16 v[160:163], v[224:227], v[96:99], v[160:163]
    v_mfma_f32_16x16x32_bf16 v[164:167], v[224:227], v[100:103], v[164:167]
    ds_read_b128 v[220:223], v11 offset:9216
    s_waitcnt lgkmcnt(8)
    v_mfma_f32_16x16x32_bf16 v[168:171], v[228:231], v[96:99], v[168:171]
    v_mfma_f32_16x16x32_bf16 v[172:175], v[228:231], v[100:103], v[172:175]
    ds_read_b128 v[224:227], v11 offset:10240
    s_waitcnt lgkmcnt(8)
    v_mfma_f32_16x16x32_bf16 v[176:179], v[232:235], v[96:99], v[176:179]
    v_mfma_f32_16x16x32_bf16 v[180:183], v[232:235], v[100:103], v[180:183]
    ds_read_b128 v[228:231], v11 offset:11264
    s_waitcnt lgkmcnt(8)
    v_mfma_f32_16x16x32_bf16 v[184:187], v[236:239], v[96:99], v[184:187]
    v_mfma_f32_16x16x32_bf16 v[188:191], v[236:239], v[100:103], v[188:191]
    ds_read_b128 v[232:235], v11 offset:12288
    s_waitcnt lgkmcnt(8)
    v_mfma_f32_16x16x32_bf16 v[192:195], v[240:243], v[96:99], v[192:195]
    v_mfma_f32_16x16x32_bf16 v[196:199], v[240:243], v[100:103], v[196:199]
    ds_read_b128 v[236:239], v11 offset:13312
    s_waitcnt lgkmcnt(8)
    v_mfma_f32_16x16x32_bf16 v[200:203], v[244:247], v[96:99], v[200:203]
    v_mfma_f32_16x16x32_bf16 v[204:207], v[244:247], v[100:103], v[204:207]
    ds_read_b128 v[240:243], v11 offset:14336
    s_waitcnt lgkmcnt(8)
    v_mfma_f32_16x16x32_bf16 v[208:211], v[248:251], v[96:99], v[208:211]
    v_mfma_f32_16x16x32_bf16 v[212:215], v[248:251], v[100:103], v[212:215]
    ds_read_b128 v[244:247], v11 offset:15360
    s_waitcnt vmcnt(9) lgkmcnt(8)
    v_mfma_f32_16x16x32_bf16 v[160:163], v[252:255], v[104:107], v[160:163]
    v_mfma_f32_16x16x32_bf16 v[164:167], v[252:255], v[108:111], v[164:167]
    ds_read_b128 v[248:251], v11 offset:16384
    s_waitcnt lgkmcnt(8)
    v_mfma_f32_16x16x32_bf16 v[168:171], v[216:219], v[104:107], v[168:171]
    v_mfma_f32_16x16x32_bf16 v[172:175], v[216:219], v[108:111], v[172:175]
    ds_read_b128 v[252:255], v11 offset:17408
    s_waitcnt lgkmcnt(8)
    v_mfma_f32_16x16x32_bf16 v[176:179], v[220:223], v[104:107], v[176:179]
    v_mfma_f32_16x16x32_bf16 v[180:183], v[220:223], v[108:111], v[180:183]
    ds_read_b128 v[216:219], v11 offset:18432
    s_waitcnt lgkmcnt(8)
    v_mfma_f32_16x16x32_bf16 v[184:187], v[224:227], v[104:107], v[184:187]
    v_mfma_f32_16x16x32_bf16 v[188:191], v[224:227], v[108:111], v[188:191]
    ds_read_b128 v[220:223], v11 offset:19456
    s_waitcnt lgkmcnt(8)
    v_mfma_f32_16x16x32_bf16 v[192:195], v[228:231], v[104:107], v[192:195]
    v_mfma_f32_16x16x32_bf16 v[196:199], v[228:231], v[108:111], v[196:199]
    ds_read_b128 v[224:227], v11 offset:20480
    s_waitcnt lgkmcnt(8)
    v_mfma_f32_16x16x32_bf16 v[200:203], v[232:235], v[104:107], v[200:203]
    v_mfma_f32_16x16x32_bf16 v[204:207], v[232:235], v[108:111], v[204:207]
    ds_read_b128 v[228:231], v11 offset:21504
    s_waitcnt lgkmcnt(8)
    v_mfma_f32_16x16x32_bf16 v[208:211], v[236:239], v[104:107], v[208:211]
    v_mfma_f32_16x16x32_bf16 v[212:215], v[236:239], v[108:111], v[212:215]
    ds_read_b128 v[232:235], v11 offset:22528
    s_waitcnt vmcnt(7) lgkmcnt(8)
    v_mfma_f32_16x16x32_bf16 v[160:163], v[240:243], v[112:115], v[160:163]
    v_mfma_f32_16x16x32_bf16 v[164:167], v[240:243], v[116:119], v[164:167]
    ds_read_b128 v[236:239], v11 offset:23552
    s_waitcnt lgkmcnt(8)
    v_mfma_f32_16x16x32_bf16 v[168:171], v[244:247], v[112:115], v[168:171]
    v_mfma_f32_16x16x32_bf16 v[172:175], v[244:247], v[116:119], v[172:175]
    ds_read_b128 v[240:243], v11 offset:24576
    s_waitcnt lgkmcnt(8)
    v_mfma_f32_16x16x32_bf16 v[176:179], v[248:251], v[112:115], v[176:179]
    v_mfma_f32_16x16x32_bf16 v[180:183], v[248:251], v[116:119], v[180:183]
    ds_read_b128 v[244:247], v11 offset:25600
    s_waitcnt lgkmcnt(8)
    v_mfma_f32_16x16x32_bf16 v[184:187], v[252:255], v[112:115], v[184:187]
    v_mfma_f32_16x16x32_bf16 v[188:191], v[252:255], v[116:119], v[188:191]
    ds_read_b128 v[248:251], v11 offset:26624
    s_waitcnt lgkmcnt(8)
    v_mfma_f32_16x16x32_bf16 v[192:195], v[216:219], v[112:115], v[192:195]
    v_mfma_f32_16x16x32_bf16 v[196:199], v[216:219], v[116:119], v[196:199]
    ds_read_b128 v[252:255], v11 offset:27648
    s_waitcnt lgkmcnt(8)
    v_mfma_f32_16x16x32_bf16 v[200:203], v[220:223], v[112:115], v[200:203]
    v_mfma_f32_16x16x32_bf16 v[204:207], v[220:223], v[116:119], v[204:207]
    s_waitcnt lgkmcnt(7)
    v_mfma_f32_16x16x32_bf16 v[208:211], v[224:227], v[112:115], v[208:211]
    v_mfma_f32_16x16x32_bf16 v[212:215], v[224:227], v[116:119], v[212:215]
    s_waitcnt vmcnt(5) lgkmcnt(6)
    v_mfma_f32_16x16x32_bf16 v[160:163], v[228:231], v[120:123], v[160:163]
    v_mfma_f32_16x16x32_bf16 v[164:167], v[228:231], v[124:127], v[164:167]
    s_waitcnt lgkmcnt(5)
    v_mfma_f32_16x16x32_bf16 v[168:171], v[232:235], v[120:123], v[168:171]
    v_mfma_f32_16x16x32_bf16 v[172:175], v[232:235], v[124:127], v[172:175]
    s_waitcnt lgkmcnt(4)
    v_mfma_f32_16x16x32_bf16 v[176:179], v[236:239], v[120:123], v[176:179]
    v_mfma_f32_16x16x32_bf16 v[180:183], v[236:239], v[124:127], v[180:183]
    s_waitcnt lgkmcnt(3)
    v_mfma_f32_16x16x32_bf16 v[184:187], v[240:243], v[120:123], v[184:187]
    v_mfma_f32_16x16x32_bf16 v[188:191], v[240:243], v[124:127], v[188:191]
    s_waitcnt lgkmcnt(2)
    v_mfma_f32_16x16x32_bf16 v[192:195], v[244:247], v[120:123], v[192:195]
    v_mfma_f32_16x16x32_bf16 v[196:199], v[244:247], v[124:127], v[196:199]
    s_waitcnt lgkmcnt(1)
    v_mfma_f32_16x16x32_bf16 v[200:203], v[248:251], v[120:123], v[200:203]
    v_mfma_f32_16x16x32_bf16 v[204:207], v[248:251], v[124:127], v[204:207]
    s_waitcnt lgkmcnt(0)
    v_mfma_f32_16x16x32_bf16 v[208:211], v[252:255], v[120:123], v[208:211]
    v_mfma_f32_16x16x32_bf16 v[212:215], v[252:255], v[124:127], v[212:215]
F_kloop_done:
    s_nop 7
    s_nop 7
    s_mul_i32 s62, s60, 55296
    s_add_u32 s62, s62, s54
    s_add_u32 s63, s62, 55296
    s_mul_i32 s64, s49, 7
    s_cmp_lg_u32 s51, 0
    s_cbranch_scc1 F_w2e0
    buffer_load_dwordx4 a[216:219], v9, s[24:27], s65 offen offset:2048
    buffer_load_dwordx4 a[220:223], v9, s[24:27], s65 offen offset:3072
    s_add_u32 s65, s65, 4096
    buffer_load_dwordx4 a[224:227], v9, s[24:27], s65 offen offset:0
    buffer_load_dwordx4 a[228:231], v9, s[24:27], s65 offen offset:1024
    buffer_load_dwordx4 a[232:235], v9, s[24:27], s65 offen offset:2048
    buffer_load_dwordx4 a[236:239], v9, s[24:27], s65 offen offset:3072
    s_add_u32 s65, s65, 4096
F_w2e0:
    s_add_u32 s66, s64, 0
    s_lshr_b32 s67, s66, 1
    s_lshl_b32 s67, s67, 10
    s_and_b32 s66, s66, 1
    s_lshl_b32 s66, s66, 3
    s_add_u32 s66, s66, s67
    v_cvt_pk_bf16_f32 v68, v160, v161
    v_cvt_pk_bf16_f32 v84, v164, v165
    v_cvt_pk_bf16_f32 v69, v162, v163
    v_cvt_pk_bf16_f32 v85, v166, v167
    v_lshlrev_b32 v64, 16, v68
    v_lshlrev_b32 v80, 16, v84
    v_and_b32 v65, 0xffff0000, v68
    v_and_b32 v81, 0xffff0000, v84
    v_lshlrev_b32 v66, 16, v69
    v_lshlrev_b32 v82, 16, v85
    v_and_b32 v67, 0xffff0000, v69
    v_and_b32 v83, 0xffff0000, v85
    v_pk_mul_f32 v[68:69], v[64:65], s[36:37]
    v_pk_mul_f32 v[84:85], v[80:81], s[36:37]
    v_pk_mul_f32 v[70:71], v[66:67], s[36:37]
    v_pk_mul_f32 v[86:87], v[82:83], s[36:37]
    v_exp_f32 v68, v68
    v_exp_f32 v84, v84
    v_exp_f32 v69, v69
    v_exp_f32 v85, v85
    v_exp_f32 v70, v70
    v_exp_f32 v86, v86
    v_exp_f32 v71, v71
    v_exp_f32 v87, v87
    v_pk_add_f32 v[68:69], v[68:69], s[38:39]
    v_pk_add_f32 v[84:85], v[84:85], s[38:39]
    v_pk_add_f32 v[70:71], v[70:71], s[38:39]
    v_pk_add_f32 v[86:87], v[86:87], s[38:39]
    v_rcp_f32 v68, v68
    v_rcp_f32 v84, v84
    v_rcp_f32 v69, v69
    v_rcp_f32 v85, v85
    v_rcp_f32 v70, v70
    v_rcp_f32 v86, v86
    v_rcp_f32 v71, v71
    v_rcp_f32 v87, v87
    v_pk_mul_f32 v[64:65], v[64:65], v[68:69]
    v_pk_mul_f32 v[80:81], v[80:81], v[84:85]
    v_pk_mul_f32 v[66:67], v[66:67], v[70:71]
    v_pk_mul_f32 v[82:83], v[82:83], v[86:87]
    v_cvt_pk_bf16_f32 v72, v64, v65
    v_cvt_pk_bf16_f32 v88, v80, v81
    v_cvt_pk_bf16_f32 v73, v66, v67
    v_cvt_pk_bf16_f32 v89, v82, v83
    s_cmp_eq_u32 s19, 0
    s_cbranch_scc1 D_slow8
    s_add_u32 s67, s62, s66
    buffer_store_dwordx2 v[72:73], v9, s[24:27], s67 offen
    s_add_u32 s67, s63, s66
    buffer_store_dwordx2 v[88:89], v9, s[24:27], s67 offen
    s_branch D_end8
D_slow8:
    s_add_u32 s67, s62, s66
    buffer_store_dwordx2 v[72:73], v9, s[24:27], s67 offen sc1
    s_add_u32 s67, s63, s66
    buffer_store_dwordx2 v[88:89], v9, s[24:27], s67 offen sc1
D_end8:
    s_cmp_lg_u32 s51, 0
    s_cbranch_scc1 F_w2e1
    buffer_load_dwordx4 a[240:243], v9, s[24:27], s65 offen offset:0
    buffer_load_dwordx4 a[244:247], v9, s[24:27], s65 offen offset:1024
    buffer_load_dwordx4 a[248:251], v9, s[24:27], s65 offen offset:2048
    buffer_load_dwordx4 a[252:255], v9, s[24:27], s65 offen offset:3072
    s_add_u32 s65, s65, 4096
    buffer_load_dwordx4 v[26:29], v9, s[24:27], s65 offen offset:0
    s_cmp_ge_u32 s50, 2
    s_cselect_b32 s65, 0x7f000000, s65
    buffer_load_dwordx4 v[30:33], v9, s[24:27], s65 offen offset:1024
F_w2e1:
    s_add_u32 s66, s64, 1
    s_lshr_b32 s67, s66, 1
    s_lshl_b32 s67, s67, 10
    s_and_b32 s66, s66, 1
    s_lshl_b32 s66, s66, 3
    s_add_u32 s66, s66, s67
    v_cvt_pk_bf16_f32 v100, v168, v169
    v_cvt_pk_bf16_f32 v116, v172, v173
    v_cvt_pk_bf16_f32 v101, v170, v171
    v_cvt_pk_bf16_f32 v117, v174, v175
    v_lshlrev_b32 v96, 16, v100
    v_lshlrev_b32 v112, 16, v116
    v_and_b32 v97, 0xffff0000, v100
    v_and_b32 v113, 0xffff0000, v116
    v_lshlrev_b32 v98, 16, v101
    v_lshlrev_b32 v114, 16, v117
    v_and_b32 v99, 0xffff0000, v101
    v_and_b32 v115, 0xffff0000, v117
    v_pk_mul_f32 v[100:101], v[96:97], s[36:37]
    v_pk_mul_f32 v[116:117], v[112:113], s[36:37]
    v_pk_mul_f32 v[102:103], v[98:99], s[36:37]
    v_pk_mul_f32 v[118:119], v[114:115], s[36:37]
    v_exp_f32 v100, v100
    v_exp_f32 v116, v116
    v_exp_f32 v101, v101
    v_exp_f32 v117, v117
    v_exp_f32 v102, v102
    v_exp_f32 v118, v118
    v_exp_f32 v103, v103
    v_exp_f32 v119, v119
    v_pk_add_f32 v[100:101], v[100:101], s[38:39]
    v_pk_add_f32 v[116:117], v[116:117], s[38:39]
    v_pk_add_f32 v[102:103], v[102:103], s[38:39]
    v_pk_add_f32 v[118:119], v[118:119], s[38:39]
    v_rcp_f32 v100, v100
    v_rcp_f32 v116, v116
    v_rcp_f32 v101, v101
    v_rcp_f32 v117, v117
    v_rcp_f32 v102, v102
    v_rcp_f32 v118, v118
    v_rcp_f32 v103, v103
    v_rcp_f32 v119, v119
    v_pk_mul_f32 v[96:97], v[96:97], v[100:101]
    v_pk_mul_f32 v[112:113], v[112:113], v[116:117]
    v_pk_mul_f32 v[98:99], v[98:99], v[102:103]
    v_pk_mul_f32 v[114:115], v[114:115], v[118:119]
    v_cvt_pk_bf16_f32 v104, v96, v97
    v_cvt_pk_bf16_f32 v120, v112, v113
    v_cvt_pk_bf16_f32 v105, v98, v99
    v_cvt_pk_bf16_f32 v121, v114, v115
    s_cmp_eq_u32 s19, 0
    s_cbranch_scc1 D_slow9
    s_add_u32 s67, s62, s66
    buffer_store_dwordx2 v[104:105], v9, s[24:27], s67 offen
    s_add_u32 s67, s63, s66
    buffer_store_dwordx2 v[120:121], v9, s[24:27], s67 offen
    s_branch D_end9
D_slow9:
    s_add_u32 s67, s62, s66
    buffer_store_dwordx2 v[104:105], v9, s[24:27], s67 offen sc1
    s_add_u32 s67, s63, s66
    buffer_store_dwordx2 v[120:121], v9, s[24:27], s67 offen sc1
D_end9:
    s_cmp_lg_u32 s51, 0
    s_cbranch_scc1 F_w2e2
    buffer_load_dwordx4 v[34:37], v9, s[24:27], s65 offen offset:2048
    buffer_load_dwordx4 v[38:41], v9, s[24:27], s65 offen offset:3072
    s_add_u32 s65, s65, 4096
    buffer_load_dwordx4 v[42:45], v9, s[24:27], s65 offen offset:0
    buffer_load_dwordx4 v[46:49], v9, s[24:27], s65 offen offset:1024
F_w2e2:
    s_add_u32 s66, s64, 2
    s_lshr_b32 s67, s66, 1
    s_lshl_b32 s67, s67, 10
    s_and_b32 s66, s66, 1
    s_lshl_b32 s66, s66, 3
    s_add_u32 s66, s66, s67
    v_cvt_pk_bf16_f32 v132, v176, v177
    v_cvt_pk_bf16_f32 v68, v180, v181
    v_cvt_pk_bf16_f32 v133, v178, v179
    v_cvt_pk_bf16_f32 v69, v182, v183
    v_lshlrev_b32 v128, 16, v132
    v_lshlrev_b32 v64, 16, v68
    v_and_b32 v129, 0xffff0000, v132
    v_and_b32 v65, 0xffff0000, v68
    v_lshlrev_b32 v130, 16, v133
    v_lshlrev_b32 v66, 16, v69
    v_and_b32 v131, 0xffff0000, v133
    v_and_b32 v67, 0xffff0000, v69
    v_pk_mul_f32 v[132:133], v[128:129], s[36:37]
    v_pk_mul_f32 v[68:69], v[64:65], s[36:37]
    v_pk_mul_f32 v[134:135], v[130:131], s[36:37]
    v_pk_mul_f32 v[70:71], v[66:67], s[36:37]
    v_exp_f32 v132, v132
    v_exp_f32 v68, v68
    v_exp_f32 v133, v133
    v_exp_f32 v69, v69
    v_exp_f32 v134, v134
    v_exp_f32 v70, v70
    v_exp_f32 v135, v135
    v_exp_f32 v71, v71
    v_pk_add_f32 v[132:133], v[132:133], s[38:39]
    v_pk_add_f32 v[68:69], v[68:69], s[38:39]
    v_pk_add_f32 v[134:135], v[134:135], s[38:39]
    v_pk_add_f32 v[70:71], v[70:71], s[38:39]
    v_rcp_f32 v132, v132
    v_rcp_f32 v68, v68
    v_rcp_f32 v133, v133
    v_rcp_f32 v69, v69
    v_rcp_f32 v134, v134
    v_rcp_f32 v70, v70
    v_rcp_f32 v135, v135
    v_rcp_f32 v71, v71
    v_pk_mul_f32 v[128:129], v[128:129], v[132:133]
    v_pk_mul_f32 v[64:65], v[64:65], v[68:69]
    v_pk_mul_f32 v[130:131], v[130:131], v[134:135]
    v_pk_mul_f32 v[66:67], v[66:67], v[70:71]
    v_cvt_pk_bf16_f32 v136, v128, v129
    v_cvt_pk_bf16_f32 v72, v64, v65
    v_cvt_pk_bf16_f32 v137, v130, v131
    v_cvt_pk_bf16_f32 v73, v66, v67
    s_cmp_eq_u32 s19, 0
    s_cbranch_scc1 D_slow10
    s_add_u32 s67, s62, s66
    buffer_store_dwordx2 v[136:137], v9, s[24:27], s67 offen
    s_add_u32 s67, s63, s66
    buffer_store_dwordx2 v[72:73], v9, s[24:27], s67 offen
    s_branch D_end10
D_slow10:
    s_add_u32 s67, s62, s66
    buffer_store_dwordx2 v[136:137], v9, s[24:27], s67 offen sc1
    s_add_u32 s67, s63, s66
    buffer_store_dwordx2 v[72:73], v9, s[24:27], s67 offen sc1
D_end10:
    s_cmp_eq_u32 s49, 15
    s_cbranch_scc1 F_epi_done
    s_add_u32 s66, s64, 3
    s_lshr_b32 s67, s66, 1
    s_lshl_b32 s67, s67, 10
    s_and_b32 s66, s66, 1
    s_lshl_b32 s66, s66, 3
    s_add_u32 s66, s66, s67
    v_cvt_pk_bf16_f32 v84, v184, v185
    v_cvt_pk_bf16_f32 v100, v188, v189
    v_cvt_pk_bf16_f32 v85, v186, v187
    v_cvt_pk_bf16_f32 v101, v190, v191
    v_lshlrev_b32 v80, 16, v84
    v_lshlrev_b32 v96, 16, v100
    v_and_b32 v81, 0xffff0000, v84
    v_and_b32 v97, 0xffff0000, v100
    v_lshlrev_b32 v82, 16, v85
    v_lshlrev_b32 v98, 16, v101
    v_and_b32 v83, 0xffff0000, v85
    v_and_b32 v99, 0xffff0000, v101
    v_pk_mul_f32 v[84:85], v[80:81], s[36:37]
    v_pk_mul_f32 v[100:101], v[96:97], s[36:37]
    v_pk_mul_f32 v[86:87], v[82:83], s[36:37]
    v_pk_mul_f32 v[102:103], v[98:99], s[36:37]
    v_exp_f32 v84, v84
    v_exp_f32 v100, v100
    v_exp_f32 v85, v85
    v_exp_f32 v101, v101
    v_exp_f32 v86, v86
    v_exp_f32 v102, v102
    v_exp_f32 v87, v87
    v_exp_f32 v103, v103
    v_pk_add_f32 v[84:85], v[84:85], s[38:39]
    v_pk_add_f32 v[100:101], v[100:101], s[38:39]
    v_pk_add_f32 v[86:87], v[86:87], s[38:39]
    v_pk_add_f32 v[102:103], v[102:103], s[38:39]
    v_rcp_f32 v84, v84
    v_rcp_f32 v100, v100
    v_rcp_f32 v85, v85
    v_rcp_f32 v101, v101
    v_rcp_f32 v86, v86
    v_rcp_f32 v102, v102
    v_rcp_f32 v87, v87
    v_rcp_f32 v103, v103
    v_pk_mul_f32 v[80:81], v[80:81], v[84:85]
    v_pk_mul_f32 v[96:97], v[96:97], v[100:101]
    v_pk_mul_f32 v[82:83], v[82:83], v[86:87]
    v_pk_mul_f32 v[98:99], v[98:99], v[102:103]
    v_cvt_pk_bf16_f32 v88, v80, v81
    v_cvt_pk_bf16_f32 v104, v96, v97
    v_cvt_pk_bf16_f32 v89, v82, v83
    v_cvt_pk_bf16_f32 v105, v98, v99
    s_cmp_eq_u32 s19, 0
    s_cbranch_scc1 D_slow11
    s_add_u32 s67, s62, s66
    buffer_store_dwordx2 v[88:89], v9, s[24:27], s67 offen
    s_add_u32 s67, s63, s66
    buffer_store_dwordx2 v[104:105], v9, s[24:27], s67 offen
    s_branch D_end11
D_slow11:
    s_add_u32 s67, s62, s66
    buffer_store_dwordx2 v[88:89], v9, s[24:27], s67 offen sc1
    s_add_u32 s67, s63, s66
    buffer_store_dwordx2 v[104:105], v9, s[24:27], s67 offen sc1
D_end11:
    s_add_u32 s66, s64, 4
    s_lshr_b32 s67, s66, 1
    s_lshl_b32 s67, s67, 10
    s_and_b32 s66, s66, 1
    s_lshl_b32 s66, s66, 3
    s_add_u32 s66, s66, s67
    v_cvt_pk_bf16_f32 v116, v192, v193
    v_cvt_pk_bf16_f32 v132, v196, v197
    v_cvt_pk_bf16_f32 v117, v194, v195
    v_cvt_pk_bf16_f32 v133, v198, v199
    v_lshlrev_b32 v112, 16, v116
    v_lshlrev_b32 v128, 16, v132
    v_and_b32 v113, 0xffff0000, v116
    v_and_b32 v129, 0xffff0000, v132
    v_lshlrev_b32 v114, 16, v117
    v_lshlrev_b32 v130, 16, v133
    v_and_b32 v115, 0xffff0000, v117
    v_and_b32 v131, 0xffff0000, v133
    v_pk_mul_f32 v[116:117], v[112:113], s[36:37]
    v_pk_mul_f32 v[132:133], v[128:129], s[36:37]
    v_pk_mul_f32 v[118:119], v[114:115], s[36:37]
    v_pk_mul_f32 v[134:135], v[130:131], s[36:37]
    v_exp_f32 v116, v116
    v_exp_f32 v132, v132
    v_exp_f32 v117, v117
    v_exp_f32 v133, v133
    v_exp_f32 v118, v118
    v_exp_f32 v134, v134
    v_exp_f32 v119, v119
    v_exp_f32 v135, v135
    v_pk_add_f32 v[116:117], v[116:117], s[38:39]
    v_pk_add_f32 v[132:133], v[132:133], s[38:39]
    v_pk_add_f32 v[118:119], v[118:119], s[38:39]
    v_pk_add_f32 v[134:135], v[134:135], s[38:39]
    v_rcp_f32 v116, v116
    v_rcp_f32 v132, v132
    v_rcp_f32 v117, v117
    v_rcp_f32 v133, v133
    v_rcp_f32 v118, v118
    v_rcp_f32 v134, v134
    v_rcp_f32 v119, v119
    v_rcp_f32 v135, v135
    v_pk_mul_f32 v[112:113], v[112:113], v[116:117]
    v_pk_mul_f32 v[128:129], v[128:129], v[132:133]
    v_pk_mul_f32 v[114:115], v[114:115], v[118:119]
    v_pk_mul_f32 v[130:131], v[130:131], v[134:135]
    v_cvt_pk_bf16_f32 v120, v112, v113
    v_cvt_pk_bf16_f32 v136, v128, v129
    v_cvt_pk_bf16_f32 v121, v114, v115
    v_cvt_pk_bf16_f32 v137, v130, v131
    s_cmp_eq_u32 s19, 0
    s_cbranch_scc1 D_slow12
    s_add_u32 s67, s62, s66
    buffer_store_dwordx2 v[120:121], v9, s[24:27], s67 offen
    s_add_u32 s67, s63, s66
    buffer_store_dwordx2 v[136:137], v9, s[24:27], s67 offen
    s_branch D_end12
D_slow12:
    s_add_u32 s67, s62, s66
    buffer_store_dwordx2 v[120:121], v9, s[24:27], s67 offen sc1
    s_add_u32 s67, s63, s66
    buffer_store_dwordx2 v[136:137], v9, s[24:27], s67 offen sc1
D_end12:
    s_add_u32 s66, s64, 5
    s_lshr_b32 s67, s66, 1
    s_lshl_b32 s67, s67, 10
    s_and_b32 s66, s66, 1
    s_lshl_b32 s66, s66, 3
    s_add_u32 s66, s66, s67
    v_cvt_pk_bf16_f32 v68, v200, v201
    v_cvt_pk_bf16_f32 v84, v204, v205
    v_cvt_pk_bf16_f32 v69, v202, v203
    v_cvt_pk_bf16_f32 v85, v206, v207
    v_lshlrev_b32 v64, 16, v68
    v_lshlrev_b32 v80, 16, v84
    v_and_b32 v65, 0xffff0000, v68
    v_and_b32 v81, 0xffff0000, v84
    v_lshlrev_b32 v66, 16, v69
    v_lshlrev_b32 v82, 16, v85
    v_and_b32 v67, 0xffff0000, v69
    v_and_b32 v83, 0xffff0000, v85
    v_pk_mul_f32 v[68:69], v[64:65], s[36:37]
    v_pk_mul_f32 v[84:85], v[80:81], s[36:37]
    v_pk_mul_f32 v[70:71], v[66:67], s[36:37]
    v_pk_mul_f32 v[86:87], v[82:83], s[36:37]
    v_exp_f32 v68, v68
    v_exp_f32 v84, v84
    v_exp_f32 v69, v69
    v_exp_f32 v85, v85
    v_exp_f32 v70, v70
    v_exp_f32 v86, v86
    v_exp_f32 v71, v71
    v_exp_f32 v87, v87
    v_pk_add_f32 v[68:69], v[68:69], s[38:39]
    v_pk_add_f32 v[84:85], v[84:85], s[38:39]
    v_pk_add_f32 v[70:71], v[70:71], s[38:39]
    v_pk_add_f32 v[86:87], v[86:87], s[38:39]
    v_rcp_f32 v68, v68
    v_rcp_f32 v84, v84
    v_rcp_f32 v69, v69
    v_rcp_f32 v85, v85
    v_rcp_f32 v70, v70
    v_rcp_f32 v86, v86
    v_rcp_f32 v71, v71
    v_rcp_f32 v87, v87
    v_pk_mul_f32 v[64:65], v[64:65], v[68:69]
    v_pk_mul_f32 v[80:81], v[80:81], v[84:85]
    v_pk_mul_f32 v[66:67], v[66:67], v[70:71]
    v_pk_mul_f32 v[82:83], v[82:83], v[86:87]
    v_cvt_pk_bf16_f32 v72, v64, v65
    v_cvt_pk_bf16_f32 v88, v80, v81
    v_cvt_pk_bf16_f32 v73, v66, v67
    v_cvt_pk_bf16_f32 v89, v82, v83
    s_cmp_eq_u32 s19, 0
    s_cbranch_scc1 D_slow13
    s_add_u32 s67, s62, s66
    buffer_store_dwordx2 v[72:73], v9, s[24:27], s67 offen
    s_add_u32 s67, s63, s66
    buffer_store_dwordx2 v[88:89], v9, s[24:27], s67 offen
    s_branch D_end13
D_slow13:
    s_add_u32 s67, s62, s66
    buffer_store_dwordx2 v[72:73], v9, s[24:27], s67 offen sc1
    s_add_u32 s67, s63, s66
    buffer_store_dwordx2 v[88:89], v9, s[24:27], s67 offen sc1
D_end13:
    s_add_u32 s66, s64, 6
    s_lshr_b32 s67, s66, 1
    s_lshl_b32 s67, s67, 10
    s_and_b32 s66, s66, 1
    s_lshl_b32 s66, s66, 3
    s_add_u32 s66, s66, s67
    v_cvt_pk_bf16_f32 v100, v208, v209
    v_cvt_pk_bf16_f32 v116, v212, v213
    v_cvt_pk_bf16_f32 v101, v210, v211
    v_cvt_pk_bf16_f32 v117, v214, v215
    v_lshlrev_b32 v96, 16, v100
    v_lshlrev_b32 v112, 16, v116
    v_and_b32 v97, 0xffff0000, v100
    v_and_b32 v113, 0xffff0000, v116
    v_lshlrev_b32 v98, 16, v101
    v_lshlrev_b32 v114, 16, v117
    v_and_b32 v99, 0xffff0000, v101
    v_and_b32 v115, 0xffff0000, v117
    v_pk_mul_f32 v[100:101], v[96:97], s[36:37]
    v_pk_mul_f32 v[116:117], v[112:113], s[36:37]
    v_pk_mul_f32 v[102:103], v[98:99], s[36:37]
    v_pk_mul_f32 v[118:119], v[114:115], s[36:37]
    v_exp_f32 v100, v100
    v_exp_f32 v116, v116
    v_exp_f32 v101, v101
    v_exp_f32 v117, v117
    v_exp_f32 v102, v102
    v_exp_f32 v118, v118
    v_exp_f32 v103, v103
    v_exp_f32 v119, v119
    v_pk_add_f32 v[100:101], v[100:101], s[38:39]
    v_pk_add_f32 v[116:117], v[116:117], s[38:39]
    v_pk_add_f32 v[102:103], v[102:103], s[38:39]
    v_pk_add_f32 v[118:119], v[118:119], s[38:39]
    v_rcp_f32 v100, v100
    v_rcp_f32 v116, v116
    v_rcp_f32 v101, v101
    v_rcp_f32 v117, v117
    v_rcp_f32 v102, v102
    v_rcp_f32 v118, v118
    v_rcp_f32 v103, v103
    v_rcp_f32 v119, v119
    v_pk_mul_f32 v[96:97], v[96:97], v[100:101]
    v_pk_mul_f32 v[112:113], v[112:113], v[116:117]
    v_pk_mul_f32 v[98:99], v[98:99], v[102:103]
    v_pk_mul_f32 v[114:115], v[114:115], v[118:119]
    v_cvt_pk_bf16_f32 v104, v96, v97
    v_cvt_pk_bf16_f32 v120, v112, v113
    v_cvt_pk_bf16_f32 v105, v98, v99
    v_cvt_pk_bf16_f32 v121, v114, v115
    s_cmp_eq_u32 s19, 0
    s_cbranch_scc1 D_slow14
    s_add_u32 s67, s62, s66
    buffer_store_dwordx2 v[104:105], v9, s[24:27], s67 offen
    s_add_u32 s67, s63, s66
    buffer_store_dwordx2 v[120:121], v9, s[24:27], s67 offen
    s_branch D_end14
D_slow14:
    s_add_u32 s67, s62, s66
    buffer_store_dwordx2 v[104:105], v9, s[24:27], s67 offen sc1
    s_add_u32 s67, s63, s66
    buffer_store_dwordx2 v[120:121], v9, s[24:27], s67 offen sc1
D_end14:
F_epi_done:
    s_waitcnt vmcnt(0)
    s_barrier
    s_cmp_lg_u32 s50, 0
    s_cbranch_scc1 F_sig1
    s_add_u32 s57, s56, 2048
    s_lshl_b32 s58, s49, 2
    s_add_u32 s57, s57, s58
    v_mov_b32 v12, 0
    v_mov_b32 v13, 1
    v_cmp_eq_u32 vcc, 0, v0
    s_nop 0
    s_and_saveexec_b64 s[58:59], vcc
    s_cmp_eq_u32 s19, 0
    s_cbranch_scc1 D_slow15
    buffer_store_dword v13, v12, s[24:27], s57 offen
    s_branch D_end15
D_slow15:
    buffer_store_dword v13, v12, s[24:27], s57 offen sc1
D_end15:
    s_mov_b64 exec, s[58:59]
F_sig1:
    s_lshl_b32 s46, s50, 2
    s_cmp_eq_u32 s50, 3
    s_cselect_b32 s47, 1, 0
    s_sub_u32 s46, s46, s47
    s_cselect_b32 s47, 31, 15
    s_lshl_b32 s46, s47, s46
    s_add_u32 s57, s56, 2048
    v_and_b32 v12, 15, v0
    v_lshlrev_b32 v12, 2, v12
    s_mov_b32 s58, 0
F_w1_poll:
    buffer_load_dword v13, v12, s[24:27], s57 offen sc1
    s_waitcnt vmcnt(0)
    v_cmp_ne_u32 vcc, 1, v13
    s_nop 1
    s_and_b32 s59, vcc_lo, s46
    s_cbranch_scc0 F_w1_ok
    s_sleep 1
    s_add_u32 s58, s58, 1
    s_cmp_lt_u32 s58, 200000
    s_cbranch_scc1 F_w1_poll
F_w1_ok:
    s_nop 7
    s_nop 7
    s_lshr_b32 s60, s49, 3
    s_and_b32 s61, s49, 7
    s_lshl_b32 s62, s48, 3
    s_lshl_b32 s63, s60, 2
    s_add_u32 s62, s62, s63
    s_mul_i32 s64, s50, 14
    s_cmp_eq_u32 s50, 3
    s_cselect_b32 s66, 1, 0
    s_sub_u32 s64, s64, s66
    s_mul_i32 s66, s62, 54
    s_add_u32 s66, s66, s64
    s_lshl_b32 s66, s66, 10
    s_add_u32 s44, s66, s54
    s_add_u32 s66, s50, 0
    s_and_b32 s66, s66, 3
    s_mul_i32 s66, s66, 55296
    s_add_u32 s40, s44, s66
    s_add_u32 s66, s50, 1
    s_and_b32 s66, s66, 3
    s_mul_i32 s66, s66, 55296
    s_add_u32 s41, s44, s66
    s_add_u32 s66, s50, 2
    s_and_b32 s66, s66, 3
    s_mul_i32 s66, s66, 55296
    s_add_u32 s42, s44, s66
    s_add_u32 s66, s50, 3
    s_and_b32 s66, s66, 3
    s_mul_i32 s66, s66, 55296
    s_add_u32 s43, s44, s66
    buffer_load_dwordx4 v[100:103], v9, s[24:27], s41 offen offset:0 sc1 nt
    buffer_load_dwordx4 v[104:107], v9, s[24:27], s41 offen offset:1024 sc1 nt
    buffer_load_dwordx4 v[108:111], v9, s[24:27], s41 offen offset:2048 sc1 nt
    buffer_load_dwordx4 v[112:115], v9, s[24:27], s41 offen offset:3072 sc1 nt
    s_add_u32 s41, s41, 4096
    buffer_load_dwordx4 v[116:119], v9, s[24:27], s41 offen offset:0 sc1 nt
    buffer_load_dwordx4 v[120:123], v9, s[24:27], s41 offen offset:1024 sc1 nt
    buffer_load_dwordx4 v[124:127], v9, s[24:27], s41 offen offset:2048 sc1 nt
    buffer_load_dwordx4 v[128:131], v9, s[24:27], s41 offen offset:3072 sc1 nt
    s_add_u32 s41, s41, 4096
    buffer_load_dwordx4 v[132:135], v9, s[24:27], s41 offen offset:0 sc1 nt
    buffer_load_dwordx4 v[136:139], v9, s[24:27], s41 offen offset:1024 sc1 nt
    buffer_load_dwordx4 v[140:143], v9, s[24:27], s41 offen offset:2048 sc1 nt
    buffer_load_dwordx4 v[144:147], v9, s[24:27], s41 offen offset:3072 sc1 nt
    s_add_u32 s41, s41, 4096
    buffer_load_dwordx4 v[148:151], v9, s[24:27], s41 offen offset:0 sc1 nt
    s_cmp_ge_u32 s50, 2
    s_cselect_b32 s41, 0x7f000000, s41
    buffer_load_dwordx4 v[152:155], v9, s[24:27], s41 offen offset:1024 sc1 nt
    buffer_load_dwordx4 v[156:159], v9, s[24:27], s42 offen offset:0 sc1 nt
    s_mul_i32 s60, s50, 5120
    s_add_u32 s60, s60, 143360
    v_add_u32 v13, s60, v9
    buffer_load_dwordx4 v[160:163], v9, s[24:27], s42 offen offset:1024 sc1 nt
    s_waitcnt vmcnt(15)
    v_mfma_f32_16x16x32_bf16 v[172:175], a[0:3], v[100:103], 0
    v_mfma_f32_16x16x32_bf16 v[188:191], a[4:7], v[100:103], 0
    v_mfma_f32_16x16x32_bf16 v[204:207], a[8:11], v[100:103], 0
    v_mfma_f32_16x16x32_bf16 v[220:223], a[12:15], v[100:103], 0
    v_mfma_f32_16x16x32_bf16 v[236:239], a[16:19], v[100:103], 0
    buffer_load_dwordx4 v[100:103], v9, s[24:27], s42 offen offset:2048 sc1 nt
    s_waitcnt vmcnt(15)
    v_mfma_f32_16x16x32_bf16 v[172:175], a[20:23], v[104:107], v[172:175]
    v_mfma_f32_16x16x32_bf16 v[188:191], a[24:27], v[104:107], v[188:191]
    v_mfma_f32_16x16x32_bf16 v[204:207], a[28:31], v[104:107], v[204:207]
    v_mfma_f32_16x16x32_bf16 v[220:223], a[32:35], v[104:107], v[220:223]
    v_mfma_f32_16x16x32_bf16 v[236:239], a[36:39], v[104:107], v[236:239]
    buffer_load_dwordx4 v[104:107], v9, s[24:27], s42 offen offset:3072 sc1 nt
    s_add_u32 s42, s42, 4096
    s_waitcnt vmcnt(15)
    v_mfma_f32_16x16x32_bf16 v[172:175], a[40:43], v[108:111], v[172:175]
    v_mfma_f32_16x16x32_bf16 v[188:191], a[44:47], v[108:111], v[188:191]
    v_mfma_f32_16x16x32_bf16 v[204:207], a[48:51], v[108:111], v[204:207]
    v_mfma_f32_16x16x32_bf16 v[220:223], a[52:55], v[108:111], v[220:223]
    v_mfma_f32_16x16x32_bf16 v[236:239], a[56:59], v[108:111], v[236:239]
    buffer_load_dwordx4 v[108:111], v9, s[24:27], s42 offen offset:0 sc1 nt
    s_waitcnt vmcnt(15)
    v_mfma_f32_16x16x32_bf16 v[172:175], a[60:63], v[112:115], v[172:175]
    v_mfma_f32_16x16x32_bf16 v[188:191], a[64:67], v[112:115], v[188:191]
    v_mfma_f32_16x16x32_bf16 v[204:207], a[68:71], v[112:115], v[204:207]
    v_mfma_f32_16x16x32_bf16 v[220:223], a[72:75], v[112:115], v[220:223]
    v_mfma_f32_16x16x32_bf16 v[236:239], a[76:79], v[112:115], v[236:239]
    buffer_load_dwordx4 v[112:115], v9, s[24:27], s42 offen offset:1024 sc1 nt
    s_waitcnt vmcnt(15)
    v_mfma_f32_16x16x32_bf16 v[172:175], a[80:83], v[116:119], v[172:175]
    v_mfma_f32_16x16x32_bf16 v[188:191], a[84:87], v[116:119], v[188:191]
    v_mfma_f32_16x16x32_bf16 v[204:207], a[88:91], v[116:119], v[204:207]
    v_mfma_f32_16x16x32_bf16 v[220:223], a[92:95], v[116:119], v[220:223]
    v_mfma_f32_16x16x32_bf16 v[236:239], a[96:99], v[116:119], v[236:239]
    buffer_load_dwordx4 v[116:119], v9, s[24:27], s42 offen offset:2048 sc1 nt
    s_waitcnt vmcnt(15)
    v_mfma_f32_16x16x32_bf16 v[172:175], a[100:103], v[120:123], v[172:175]
    v_mfma_f32_16x16x32_bf16 v[188:191], a[104:107], v[120:123], v[188:191]
    v_mfma_f32_16x16x32_bf16 v[204:207], a[108:111], v[120:123], v[204:207]
    v_mfma_f32_16x16x32_bf16 v[220:223], a[112:115], v[120:123], v[220:223]
    v_mfma_f32_16x16x32_bf16 v[236:239], a[116:119], v[120:123], v[236:239]
    buffer_load_dwordx4 v[120:123], v9, s[24:27], s42 offen offset:3072 sc1 nt
    s_add_u32 s42, s42, 4096
    s_waitcnt vmcnt(15)
    v_mfma_f32_16x16x32_bf16 v[172:175], a[120:123], v[124:127], v[172:175]
    v_mfma_f32_16x16x32_bf16 v[188:191], a[124:127], v[124:127], v[188:191]
    v_mfma_f32_16x16x32_bf16 v[204:207], a[128:131], v[124:127], v[204:207]
    v_mfma_f32_16x16x32_bf16 v[220:223], a[132:135], v[124:127], v[220:223]
    v_mfma_f32_16x16x32_bf16 v[236:239], a[136:139], v[124:127], v[236:239]
    buffer_load_dwordx4 v[124:127], v9, s[24:27], s42 offen offset:0 sc1 nt
    s_waitcnt vmcnt(15)
    v_mfma_f32_16x16x32_bf16 v[172:175], a[140:143], v[128:131], v[172:175]
    v_mfma_f32_16x16x32_bf16 v[188:191], a[144:147], v[128:131], v[188:191]
    v_mfma_f32_16x16x32_bf16 v[204:207], a[148:151], v[128:131], v[204:207]
    v_mfma_f32_16x16x32_bf16 v[220:223], a[152:155], v[128:131], v[220:223]
    v_mfma_f32_16x16x32_bf16 v[236:239], a[156:159], v[128:131], v[236:239]
    buffer_load_dwordx4 v[128:131], v9, s[24:27], s42 offen offset:1024 sc1 nt
    s_waitcnt vmcnt(15)
    v_mfma_f32_16x16x32_bf16 v[172:175], a[160:163], v[132:135], v[172:175]
    v_mfma_f32_16x16x32_bf16 v[188:191], a[164:167], v[132:135], v[188:191]
    v_mfma_f32_16x16x32_bf16 v[204:207], a[168:171], v[132:135], v[204:207]
    v_mfma_f32_16x16x32_bf16 v[220:223], a[172:175], v[132:135], v[220:223]
    v_mfma_f32_16x16x32_bf16 v[236:239], a[176:179], v[132:135], v[236:239]
    buffer_load_dwordx4 v[132:135], v9, s[24:27], s42 offen offset:2048 sc1 nt
    s_waitcnt vmcnt(15)
    v_mfma_f32_16x16x32_bf16 v[172:175], a[180:183], v[136:139], v[172:175]
    v_mfma_f32_16x16x32_bf16 v[188:191], a[184:187], v[136:139], v[188:191]
    v_mfma_f32_16x16x32_bf16 v[204:207], a[188:191], v[136:139], v[204:207]
    v_mfma_f32_16x16x32_bf16 v[220:223], a[192:195], v[136:139], v[220:223]
    v_mfma_f32_16x16x32_bf16 v[236:239], a[196:199], v[136:139], v[236:239]
    buffer_load_dwordx4 v[136:139], v9, s[24:27], s42 offen offset:3072 sc1 nt
    s_add_u32 s42, s42, 4096
    s_waitcnt vmcnt(15)
    v_mfma_f32_16x16x32_bf16 v[172:175], a[200:203], v[140:143], v[172:175]
    v_mfma_f32_16x16x32_bf16 v[188:191], a[204:207], v[140:143], v[188:191]
    v_mfma_f32_16x16x32_bf16 v[204:207], a[208:211], v[140:143], v[204:207]
    v_mfma_f32_16x16x32_bf16 v[220:223], a[212:215], v[140:143], v[220:223]
    v_mfma_f32_16x16x32_bf16 v[236:239], a[216:219], v[140:143], v[236:239]
    buffer_load_dwordx4 v[140:143], v9, s[24:27], s42 offen offset:0 sc1 nt
    s_waitcnt vmcnt(15)
    v_mfma_f32_16x16x32_bf16 v[172:175], a[220:223], v[144:147], v[172:175]
    v_mfma_f32_16x16x32_bf16 v[188:191], a[224:227], v[144:147], v[188:191]
    v_mfma_f32_16x16x32_bf16 v[204:207], a[228:231], v[144:147], v[204:207]
    v_mfma_f32_16x16x32_bf16 v[220:223], a[232:235], v[144:147], v[220:223]
    v_mfma_f32_16x16x32_bf16 v[236:239], a[236:239], v[144:147], v[236:239]
    s_cmp_ge_u32 s50, 2
    s_cselect_b32 s42, 0x7f000000, s42
    buffer_load_dwordx4 v[144:147], v9, s[24:27], s42 offen offset:1024 sc1 nt
    s_waitcnt vmcnt(15)
    v_mfma_f32_16x16x32_bf16 v[172:175], a[240:243], v[148:151], v[172:175]
    v_mfma_f32_16x16x32_bf16 v[188:191], a[244:247], v[148:151], v[188:191]
    v_mfma_f32_16x16x32_bf16 v[204:207], a[248:251], v[148:151], v[204:207]
    v_mfma_f32_16x16x32_bf16 v[220:223], a[252:255], v[148:151], v[220:223]
    v_mfma_f32_16x16x32_bf16 v[236:239], v[26:29], v[148:151], v[236:239]
    buffer_load_dwordx4 v[148:151], v9, s[24:27], s43 offen offset:0 sc1 nt
    s_waitcnt vmcnt(15)
    v_mfma_f32_16x16x32_bf16 v[172:175], v[30:33], v[152:155], v[172:175]
    v_mfma_f32_16x16x32_bf16 v[188:191], v[34:37], v[152:155], v[188:191]
    v_mfma_f32_16x16x32_bf16 v[204:207], v[38:41], v[152:155], v[204:207]
    v_mfma_f32_16x16x32_bf16 v[220:223], v[42:45], v[152:155], v[220:223]
    v_mfma_f32_16x16x32_bf16 v[236:239], v[46:49], v[152:155], v[236:239]
    buffer_load_dwordx4 v[152:155], v9, s[24:27], s43 offen offset:1024 sc1 nt
    s_waitcnt vmcnt(15)
    v_mfma_f32_16x16x32_bf16 v[176:179], a[0:3], v[156:159], 0
    v_mfma_f32_16x16x32_bf16 v[192:195], a[4:7], v[156:159], 0
    v_mfma_f32_16x16x32_bf16 v[208:211], a[8:11], v[156:159], 0
    v_mfma_f32_16x16x32_bf16 v[224:227], a[12:15], v[156:159], 0
    v_mfma_f32_16x16x32_bf16 v[240:243], a[16:19], v[156:159], 0
    s_add_u32 s60, s50, 1
    s_and_b32 s60, s60, 3
    s_mul_i32 s60, s60, 5120
    s_add_u32 s60, s60, 143360
    v_add_u32 v12, s60, v9
    ds_write_b128 v12, v[172:175] offset:0
    ds_write_b128 v12, v[188:191] offset:1024
    ds_write_b128 v12, v[204:207] offset:2048
    ds_write_b128 v12, v[220:223] offset:3072
    ds_write_b128 v12, v[236:239] offset:4096
    buffer_load_dwordx4 v[156:159], v9, s[24:27], s43 offen offset:2048 sc1 nt
    s_waitcnt vmcnt(15)
    v_mfma_f32_16x16x32_bf16 v[176:179], a[20:23], v[160:163], v[176:179]
    v_mfma_f32_16x16x32_bf16 v[192:195], a[24:27], v[160:163], v[192:195]
    v_mfma_f32_16x16x32_bf16 v[208:211], a[28:31], v[160:163], v[208:211]
    v_mfma_f32_16x16x32_bf16 v[224:227], a[32:35], v[160:163], v[224:227]
    v_mfma_f32_16x16x32_bf16 v[240:243], a[36:39], v[160:163], v[240:243]
    buffer_load_dwordx4 v[160:163], v9, s[24:27], s43 offen offset:3072 sc1 nt
    s_add_u32 s43, s43, 4096
    s_waitcnt vmcnt(15)
    v_mfma_f32_16x16x32_bf16 v[176:179], a[40:43], v[100:103], v[176:179]
    v_mfma_f32_16x16x32_bf16 v[192:195], a[44:47], v[100:103], v[192:195]
    v_mfma_f32_16x16x32_bf16 v[208:211], a[48:51], v[100:103], v[208:211]
    v_mfma_f32_16x16x32_bf16 v[224:227], a[52:55], v[100:103], v[224:227]
    v_mfma_f32_16x16x32_bf16 v[240:243], a[56:59], v[100:103], v[240:243]
    buffer_load_dwordx4 v[100:103], v9, s[24:27], s43 offen offset:0 sc1 nt
    s_waitcnt vmcnt(15)
    v_mfma_f32_16x16x32_bf16 v[176:179], a[60:63], v[104:107], v[176:179]
    v_mfma_f32_16x16x32_bf16 v[192:195], a[64:67], v[104:107], v[192:195]
    v_mfma_f32_16x16x32_bf16 v[208:211], a[68:71], v[104:107], v[208:211]
    v_mfma_f32_16x16x32_bf16 v[224:227], a[72:75], v[104:107], v[224:227]
    v_mfma_f32_16x16x32_bf16 v[240:243], a[76:79], v[104:107], v[240:243]
    s_waitcnt lgkmcnt(0)
    s_barrier
    ds_read_b128 v[72:75], v13 offset:0
    ds_read_b128 v[76:79], v13 offset:1024
    ds_read_b128 v[80:83], v13 offset:2048
    ds_read_b128 v[84:87], v13 offset:3072
    ds_read_b128 v[88:91], v13 offset:4096
    buffer_load_dwordx4 v[104:107], v9, s[24:27], s43 offen offset:1024 sc1 nt
    s_waitcnt vmcnt(15)
    v_mfma_f32_16x16x32_bf16 v[176:179], a[80:83], v[108:111], v[176:179]
    v_mfma_f32_16x16x32_bf16 v[192:195], a[84:87], v[108:111], v[192:195]
    v_mfma_f32_16x16x32_bf16 v[208:211], a[88:91], v[108:111], v[208:211]
    v_mfma_f32_16x16x32_bf16 v[224:227], a[92:95], v[108:111], v[224:227]
    v_mfma_f32_16x16x32_bf16 v[240:243], a[96:99], v[108:111], v[240:243]
    buffer_load_dwordx4 v[108:111], v9, s[24:27], s43 offen offset:2048 sc1 nt
    s_waitcnt vmcnt(15)
    v_mfma_f32_16x16x32_bf16 v[176:179], a[100:103], v[112:115], v[176:179]
    v_mfma_f32_16x16x32_bf16 v[192:195], a[104:107], v[112:115], v[192:195]
    v_mfma_f32_16x16x32_bf16 v[208:211], a[108:111], v[112:115], v[208:211]
    v_mfma_f32_16x16x32_bf16 v[224:227], a[112:115], v[112:115], v[224:227]
    v_mfma_f32_16x16x32_bf16 v[240:243], a[116:119], v[112:115], v[240:243]
    buffer_load_dwordx4 v[112:115], v9, s[24:27], s43 offen offset:3072 sc1 nt
    s_add_u32 s43, s43, 4096
    s_waitcnt vmcnt(15)
    v_mfma_f32_16x16x32_bf16 v[176:179], a[120:123], v[116:119], v[176:179]
    v_mfma_f32_16x16x32_bf16 v[192:195], a[124:127], v[116:119], v[192:195]
    v_mfma_f32_16x16x32_bf16 v[208:211], a[128:131], v[116:119], v[208:211]
    v_mfma_f32_16x16x32_bf16 v[224:227], a[132:135], v[116:119], v[224:227]
    v_mfma_f32_16x16x32_bf16 v[240:243], a[136:139], v[116:119], v[240:243]
    s_waitcnt lgkmcnt(0)
    buffer_load_dwordx4 v[116:119], v9, s[24:27], s43 offen offset:0 sc1 nt
    s_waitcnt vmcnt(15)
    v_mfma_f32_16x16x32_bf16 v[176:179], a[140:143], v[120:123], v[176:179]
    v_mfma_f32_16x16x32_bf16 v[192:195], a[144:147], v[120:123], v[192:195]
    v_mfma_f32_16x16x32_bf16 v[208:211], a[148:151], v[120:123], v[208:211]
    v_mfma_f32_16x16x32_bf16 v[224:227], a[152:155], v[120:123], v[224:227]
    v_mfma_f32_16x16x32_bf16 v[240:243], a[156:159], v[120:123], v[240:243]
    buffer_load_dwordx4 v[120:123], v9, s[24:27], s43 offen offset:1024 sc1 nt
    s_waitcnt vmcnt(15)
    v_mfma_f32_16x16x32_bf16 v[176:179], a[160:163], v[124:127], v[176:179]
    v_mfma_f32_16x16x32_bf16 v[192:195], a[164:167], v[124:127], v[192:195]
    v_mfma_f32_16x16x32_bf16 v[208:211], a[168:171], v[124:127], v[208:211]
    v_mfma_f32_16x16x32_bf16 v[224:227], a[172:175], v[124:127], v[224:227]
    v_mfma_f32_16x16x32_bf16 v[240:243], a[176:179], v[124:127], v[240:243]
    buffer_load_dwordx4 v[124:127], v9, s[24:27], s43 offen offset:2048 sc1 nt
    s_waitcnt vmcnt(15)
    v_mfma_f32_16x16x32_bf16 v[176:179], a[180:183], v[128:131], v[176:179]
    v_mfma_f32_16x16x32_bf16 v[192:195], a[184:187], v[128:131], v[192:195]
    v_mfma_f32_16x16x32_bf16 v[208:211], a[188:191], v[128:131], v[208:211]
    v_mfma_f32_16x16x32_bf16 v[224:227], a[192:195], v[128:131], v[224:227]
    v_mfma_f32_16x16x32_bf16 v[240:243], a[196:199], v[128:131], v[240:243]
    buffer_load_dwordx4 v[128:131], v9, s[24:27], s43 offen offset:3072 sc1 nt
    s_add_u32 s43, s43, 4096
    s_waitcnt vmcnt(15)
    v_mfma_f32_16x16x32_bf16 v[176:179], a[200:203], v[132:135], v[176:179]
    v_mfma_f32_16x16x32_bf16 v[192:195], a[204:207], v[132:135], v[192:195]
    v_mfma_f32_16x16x32_bf16 v[208:211], a[208:211], v[132:135], v[208:211]
    v_mfma_f32_16x16x32_bf16 v[224:227], a[212:215], v[132:135], v[224:227]
    v_mfma_f32_16x16x32_bf16 v[240:243], a[216:219], v[132:135], v[240:243]
    buffer_load_dwordx4 v[132:135], v9, s[24:27], s43 offen offset:0 sc1 nt
    s_waitcnt vmcnt(15)
    v_mfma_f32_16x16x32_bf16 v[176:179], a[220:223], v[136:139], v[176:179]
    v_mfma_f32_16x16x32_bf16 v[192:195], a[224:227], v[136:139], v[192:195]
    v_mfma_f32_16x16x32_bf16 v[208:211], a[228:231], v[136:139], v[208:211]
    v_mfma_f32_16x16x32_bf16 v[224:227], a[232:235], v[136:139], v[224:227]
    v_mfma_f32_16x16x32_bf16 v[240:243], a[236:239], v[136:139], v[240:243]
    s_cmp_ge_u32 s50, 2
    s_cselect_b32 s43, 0x7f000000, s43
    buffer_load_dwordx4 v[136:139], v9, s[24:27], s43 offen offset:1024 sc1 nt
    s_waitcnt vmcnt(15)
    v_mfma_f32_16x16x32_bf16 v[176:179], a[240:243], v[140:143], v[176:179]
    v_mfma_f32_16x16x32_bf16 v[192:195], a[244:247], v[140:143], v[192:195]
    v_mfma_f32_16x16x32_bf16 v[208:211], a[248:251], v[140:143], v[208:211]
    v_mfma_f32_16x16x32_bf16 v[224:227], a[252:255], v[140:143], v[224:227]
    v_mfma_f32_16x16x32_bf16 v[240:243], v[26:29], v[140:143], v[240:243]
    buffer_load_dwordx4 v[140:143], v9, s[24:27], s40 offen offset:0 sc1 nt
    s_waitcnt vmcnt(15)
    v_mfma_f32_16x16x32_bf16 v[176:179], v[30:33], v[144:147], v[176:179]
    v_mfma_f32_16x16x32_bf16 v[192:195], v[34:37], v[144:147], v[192:195]
    v_mfma_f32_16x16x32_bf16 v[208:211], v[38:41], v[144:147], v[208:211]
    v_mfma_f32_16x16x32_bf16 v[224:227], v[42:45], v[144:147], v[224:227]
    v_mfma_f32_16x16x32_bf16 v[240:243], v[46:49], v[144:147], v[240:243]
    buffer_load_dwordx4 v[144:147], v9, s[24:27], s40 offen offset:1024 sc1 nt
    s_waitcnt vmcnt(15)
    v_mfma_f32_16x16x32_bf16 v[180:183], a[0:3], v[148:151], 0
    v_mfma_f32_16x16x32_bf16 v[196:199], a[4:7], v[148:151], 0
    v_mfma_f32_16x16x32_bf16 v[212:215], a[8:11], v[148:151], 0
    v_mfma_f32_16x16x32_bf16 v[228:231], a[12:15], v[148:151], 0
    v_mfma_f32_16x16x32_bf16 v[244:247], a[16:19], v[148:151], 0
    s_add_u32 s60, s50, 2
    s_and_b32 s60, s60, 3
    s_mul_i32 s60, s60, 5120
    s_add_u32 s60, s60, 143360
    v_add_u32 v12, s60, v9
    s_barrier
    ds_write_b128 v12, v[176:179] offset:0
    ds_write_b128 v12, v[192:195] offset:1024
    ds_write_b128 v12, v[208:211] offset:2048
    ds_write_b128 v12, v[224:227] offset:3072
    ds_write_b128 v12, v[240:243] offset:4096
    buffer_load_dwordx4 v[148:151], v9, s[24:27], s40 offen offset:2048 sc1 nt
    s_waitcnt vmcnt(15)
    v_mfma_f32_16x16x32_bf16 v[180:183], a[20:23], v[152:155], v[180:183]
    v_mfma_f32_16x16x32_bf16 v[196:199], a[24:27], v[152:155], v[196:199]
    v_mfma_f32_16x16x32_bf16 v[212:215], a[28:31], v[152:155], v[212:215]
    v_mfma_f32_16x16x32_bf16 v[228:231], a[32:35], v[152:155], v[228:231]
    v_mfma_f32_16x16x32_bf16 v[244:247], a[36:39], v[152:155], v[244:247]
    buffer_load_dwordx4 v[152:155], v9, s[24:27], s40 offen offset:3072 sc1 nt
    s_add_u32 s40, s40, 4096
    s_waitcnt vmcnt(15)
    v_mfma_f32_16x16x32_bf16 v[180:183], a[40:43], v[156:159], v[180:183]
    v_mfma_f32_16x16x32_bf16 v[196:199], a[44:47], v[156:159], v[196:199]
    v_mfma_f32_16x16x32_bf16 v[212:215], a[48:51], v[156:159], v[212:215]
    v_mfma_f32_16x16x32_bf16 v[228:231], a[52:55], v[156:159], v[228:231]
    v_mfma_f32_16x16x32_bf16 v[244:247], a[56:59], v[156:159], v[244:247]
    buffer_load_dwordx4 v[156:159], v9, s[24:27], s40 offen offset:0 sc1 nt
    s_waitcnt vmcnt(15)
    v_mfma_f32_16x16x32_bf16 v[180:183], a[60:63], v[160:163], v[180:183]
    v_mfma_f32_16x16x32_bf16 v[196:199], a[64:67], v[160:163], v[196:199]
    v_mfma_f32_16x16x32_bf16 v[212:215], a[68:71], v[160:163], v[212:215]
    v_mfma_f32_16x16x32_bf16 v[228:231], a[72:75], v[160:163], v[228:231]
    v_mfma_f32_16x16x32_bf16 v[244:247], a[76:79], v[160:163], v[244:247]
    s_waitcnt lgkmcnt(0)
    s_barrier
    ds_read_b128 v[52:55], v13 offset:0
    ds_read_b128 v[56:59], v13 offset:1024
    ds_read_b128 v[60:63], v13 offset:2048
    ds_read_b128 v[64:67], v13 offset:3072
    ds_read_b128 v[68:71], v13 offset:4096
    buffer_load_dwordx4 v[160:163], v9, s[24:27], s40 offen offset:1024 sc1 nt
    s_waitcnt vmcnt(15)
    v_mfma_f32_16x16x32_bf16 v[180:183], a[80:83], v[100:103], v[180:183]
    v_mfma_f32_16x16x32_bf16 v[196:199], a[84:87], v[100:103], v[196:199]
    v_mfma_f32_16x16x32_bf16 v[212:215], a[88:91], v[100:103], v[212:215]
    v_mfma_f32_16x16x32_bf16 v[228:231], a[92:95], v[100:103], v[228:231]
    v_mfma_f32_16x16x32_bf16 v[244:247], a[96:99], v[100:103], v[244:247]
    buffer_load_dwordx4 v[100:103], v9, s[24:27], s40 offen offset:2048 sc1 nt
    s_waitcnt vmcnt(15)
    v_mfma_f32_16x16x32_bf16 v[180:183], a[100:103], v[104:107], v[180:183]
    v_mfma_f32_16x16x32_bf16 v[196:199], a[104:107], v[104:107], v[196:199]
    v_mfma_f32_16x16x32_bf16 v[212:215], a[108:111], v[104:107], v[212:215]
    v_mfma_f32_16x16x32_bf16 v[228:231], a[112:115], v[104:107], v[228:231]
    v_mfma_f32_16x16x32_bf16 v[244:247], a[116:119], v[104:107], v[244:247]
    buffer_load_dwordx4 v[104:107], v9, s[24:27], s40 offen offset:3072 sc1 nt
    s_add_u32 s40, s40, 4096
    s_waitcnt vmcnt(15)
    v_mfma_f32_16x16x32_bf16 v[180:183], a[120:123], v[108:111], v[180:183]
    v_mfma_f32_16x16x32_bf16 v[196:199], a[124:127], v[108:111], v[196:199]
    v_mfma_f32_16x16x32_bf16 v[212:215], a[128:131], v[108:111], v[212:215]
    v_mfma_f32_16x16x32_bf16 v[228:231], a[132:135], v[108:111], v[228:231]
    v_mfma_f32_16x16x32_bf16 v[244:247], a[136:139], v[108:111], v[244:247]
    s_waitcnt lgkmcnt(0)
    v_pk_add_f32 v[72:73], v[72:73], v[52:53]
    v_pk_add_f32 v[74:75], v[74:75], v[54:55]
    v_pk_add_f32 v[76:77], v[76:77], v[56:57]
    v_pk_add_f32 v[78:79], v[78:79], v[58:59]
    v_pk_add_f32 v[80:81], v[80:81], v[60:61]
    v_pk_add_f32 v[82:83], v[82:83], v[62:63]
    v_pk_add_f32 v[84:85], v[84:85], v[64:65]
    v_pk_add_f32 v[86:87], v[86:87], v[66:67]
    v_pk_add_f32 v[88:89], v[88:89], v[68:69]
    v_pk_add_f32 v[90:91], v[90:91], v[70:71]
    buffer_load_dwordx4 v[108:111], v9, s[24:27], s40 offen offset:0 sc1 nt
    s_waitcnt vmcnt(15)
    v_mfma_f32_16x16x32_bf16 v[180:183], a[140:143], v[112:115], v[180:183]
    v_mfma_f32_16x16x32_bf16 v[196:199], a[144:147], v[112:115], v[196:199]
    v_mfma_f32_16x16x32_bf16 v[212:215], a[148:151], v[112:115], v[212:215]
    v_mfma_f32_16x16x32_bf16 v[228:231], a[152:155], v[112:115], v[228:231]
    v_mfma_f32_16x16x32_bf16 v[244:247], a[156:159], v[112:115], v[244:247]
    buffer_load_dwordx4 v[112:115], v9, s[24:27], s40 offen offset:1024 sc1 nt
    s_waitcnt vmcnt(15)
    v_mfma_f32_16x16x32_bf16 v[180:183], a[160:163], v[116:119], v[180:183]
    v_mfma_f32_16x16x32_bf16 v[196:199], a[164:167], v[116:119], v[196:199]
    v_mfma_f32_16x16x32_bf16 v[212:215], a[168:171], v[116:119], v[212:215]
    v_mfma_f32_16x16x32_bf16 v[228:231], a[172:175], v[116:119], v[228:231]
    v_mfma_f32_16x16x32_bf16 v[244:247], a[176:179], v[116:119], v[244:247]
    buffer_load_dwordx4 v[116:119], v9, s[24:27], s40 offen offset:2048 sc1 nt
    s_waitcnt vmcnt(15)
    v_mfma_f32_16x16x32_bf16 v[180:183], a[180:183], v[120:123], v[180:183]
    v_mfma_f32_16x16x32_bf16 v[196:199], a[184:187], v[120:123], v[196:199]
    v_mfma_f32_16x16x32_bf16 v[212:215], a[188:191], v[120:123], v[212:215]
    v_mfma_f32_16x16x32_bf16 v[228:231], a[192:195], v[120:123], v[228:231]
    v_mfma_f32_16x16x32_bf16 v[244:247], a[196:199], v[120:123], v[244:247]
    buffer_load_dwordx4 v[120:123], v9, s[24:27], s40 offen offset:3072 sc1 nt
    s_add_u32 s40, s40, 4096
    s_waitcnt vmcnt(15)
    v_mfma_f32_16x16x32_bf16 v[180:183], a[200:203], v[124:127], v[180:183]
    v_mfma_f32_16x16x32_bf16 v[196:199], a[204:207], v[124:127], v[196:199]
    v_mfma_f32_16x16x32_bf16 v[212:215], a[208:211], v[124:127], v[212:215]
    v_mfma_f32_16x16x32_bf16 v[228:231], a[212:215], v[124:127], v[228:231]
    v_mfma_f32_16x16x32_bf16 v[244:247], a[216:219], v[124:127], v[244:247]
    buffer_load_dwordx4 v[124:127], v9, s[24:27], s40 offen offset:0 sc1 nt
    s_waitcnt vmcnt(15)
    v_mfma_f32_16x16x32_bf16 v[180:183], a[220:223], v[128:131], v[180:183]
    v_mfma_f32_16x16x32_bf16 v[196:199], a[224:227], v[128:131], v[196:199]
    v_mfma_f32_16x16x32_bf16 v[212:215], a[228:231], v[128:131], v[212:215]
    v_mfma_f32_16x16x32_bf16 v[228:231], a[232:235], v[128:131], v[228:231]
    v_mfma_f32_16x16x32_bf16 v[244:247], a[236:239], v[128:131], v[244:247]
    s_cmp_ge_u32 s50, 2
    s_cselect_b32 s40, 0x7f000000, s40
    buffer_load_dwordx4 v[128:131], v9, s[24:27], s40 offen offset:1024 sc1 nt
    s_waitcnt vmcnt(15)
    v_mfma_f32_16x16x32_bf16 v[180:183], a[240:243], v[132:135], v[180:183]
    v_mfma_f32_16x16x32_bf16 v[196:199], a[244:247], v[132:135], v[196:199]
    v_mfma_f32_16x16x32_bf16 v[212:215], a[248:251], v[132:135], v[212:215]
    v_mfma_f32_16x16x32_bf16 v[228:231], a[252:255], v[132:135], v[228:231]
    v_mfma_f32_16x16x32_bf16 v[244:247], v[26:29], v[132:135], v[244:247]
    s_waitcnt vmcnt(14)
    v_mfma_f32_16x16x32_bf16 v[180:183], v[30:33], v[136:139], v[180:183]
    v_mfma_f32_16x16x32_bf16 v[196:199], v[34:37], v[136:139], v[196:199]
    v_mfma_f32_16x16x32_bf16 v[212:215], v[38:41], v[136:139], v[212:215]
    v_mfma_f32_16x16x32_bf16 v[228:231], v[42:45], v[136:139], v[228:231]
    v_mfma_f32_16x16x32_bf16 v[244:247], v[46:49], v[136:139], v[244:247]
    s_waitcnt vmcnt(13)
    v_mfma_f32_16x16x32_bf16 v[168:171], a[0:3], v[140:143], 0
    v_mfma_f32_16x16x32_bf16 v[184:187], a[4:7], v[140:143], 0
    v_mfma_f32_16x16x32_bf16 v[200:203], a[8:11], v[140:143], 0
    v_mfma_f32_16x16x32_bf16 v[216:219], a[12:15], v[140:143], 0
    v_mfma_f32_16x16x32_bf16 v[232:235], a[16:19], v[140:143], 0
    s_add_u32 s60, s50, 3
    s_and_b32 s60, s60, 3
    s_mul_i32 s60, s60, 5120
    s_add_u32 s60, s60, 143360
    v_add_u32 v12, s60, v9
    s_barrier
    ds_write_b128 v12, v[180:183] offset:0
    ds_write_b128 v12, v[196:199] offset:1024
    ds_write_b128 v12, v[212:215] offset:2048
    ds_write_b128 v12, v[228:231] offset:3072
    ds_write_b128 v12, v[244:247] offset:4096
    s_waitcnt vmcnt(12)
    v_mfma_f32_16x16x32_bf16 v[168:171], a[20:23], v[144:147], v[168:171]
    v_mfma_f32_16x16x32_bf16 v[184:187], a[24:27], v[144:147], v[184:187]
    v_mfma_f32_16x16x32_bf16 v[200:203], a[28:31], v[144:147], v[200:203]
    v_mfma_f32_16x16x32_bf16 v[216:219], a[32:35], v[144:147], v[216:219]
    v_mfma_f32_16x16x32_bf16 v[232:235], a[36:39], v[144:147], v[232:235]
    s_waitcnt vmcnt(11)
    v_mfma_f32_16x16x32_bf16 v[168:171], a[40:43], v[148:151], v[168:171]
    v_mfma_f32_16x16x32_bf16 v[184:187], a[44:47], v[148:151], v[184:187]
    v_mfma_f32_16x16x32_bf16 v[200:203], a[48:51], v[148:151], v[200:203]
    v_mfma_f32_16x16x32_bf16 v[216:219], a[52:55], v[148:151], v[216:219]
    v_mfma_f32_16x16x32_bf16 v[232:235], a[56:59], v[148:151], v[232:235]
    s_waitcnt vmcnt(10)
    v_mfma_f32_16x16x32_bf16 v[168:171], a[60:63], v[152:155], v[168:171]
    v_mfma_f32_16x16x32_bf16 v[184:187], a[64:67], v[152:155], v[184:187]
    v_mfma_f32_16x16x32_bf16 v[200:203], a[68:71], v[152:155], v[200:203]
    v_mfma_f32_16x16x32_bf16 v[216:219], a[72:75], v[152:155], v[216:219]
    v_mfma_f32_16x16x32_bf16 v[232:235], a[76:79], v[152:155], v[232:235]
    s_waitcnt lgkmcnt(0)
    s_barrier
    ds_read_b128 v[52:55], v13 offset:0
    ds_read_b128 v[56:59], v13 offset:1024
    ds_read_b128 v[60:63], v13 offset:2048
    ds_read_b128 v[64:67], v13 offset:3072
    ds_read_b128 v[68:71], v13 offset:4096
    s_waitcnt vmcnt(9)
    v_mfma_f32_16x16x32_bf16 v[168:171], a[80:83], v[156:159], v[168:171]
    v_mfma_f32_16x16x32_bf16 v[184:187], a[84:87], v[156:159], v[184:187]
    v_mfma_f32_16x16x32_bf16 v[200:203], a[88:91], v[156:159], v[200:203]
    v_mfma_f32_16x16x32_bf16 v[216:219], a[92:95], v[156:159], v[216:219]
    v_mfma_f32_16x16x32_bf16 v[232:235], a[96:99], v[156:159], v[232:235]
    s_waitcnt vmcnt(8)
    v_mfma_f32_16x16x32_bf16 v[168:171], a[100:103], v[160:163], v[168:171]
    v_mfma_f32_16x16x32_bf16 v[184:187], a[104:107], v[160:163], v[184:187]
    v_mfma_f32_16x16x32_bf16 v[200:203], a[108:111], v[160:163], v[200:203]
    v_mfma_f32_16x16x32_bf16 v[216:219], a[112:115], v[160:163], v[216:219]
    v_mfma_f32_16x16x32_bf16 v[232:235], a[116:119], v[160:163], v[232:235]
    s_waitcnt vmcnt(7)
    v_mfma_f32_16x16x32_bf16 v[168:171], a[120:123], v[100:103], v[168:171]
    v_mfma_f32_16x16x32_bf16 v[184:187], a[124:127], v[100:103], v[184:187]
    v_mfma_f32_16x16x32_bf16 v[200:203], a[128:131], v[100:103], v[200:203]
    v_mfma_f32_16x16x32_bf16 v[216:219], a[132:135], v[100:103], v[216:219]
    v_mfma_f32_16x16x32_bf16 v[232:235], a[136:139], v[100:103], v[232:235]
    s_waitcnt lgkmcnt(0)
    v_pk_add_f32 v[72:73], v[72:73], v[52:53]
    v_pk_add_f32 v[74:75], v[74:75], v[54:55]
    v_pk_add_f32 v[76:77], v[76:77], v[56:57]
    v_pk_add_f32 v[78:79], v[78:79], v[58:59]
    v_pk_add_f32 v[80:81], v[80:81], v[60:61]
    v_pk_add_f32 v[82:83], v[82:83], v[62:63]
    v_pk_add_f32 v[84:85], v[84:85], v[64:65]
    v_pk_add_f32 v[86:87], v[86:87], v[66:67]
    v_pk_add_f32 v[88:89], v[88:89], v[68:69]
    v_pk_add_f32 v[90:91], v[90:91], v[70:71]
    s_waitcnt vmcnt(6)
    v_mfma_f32_16x16x32_bf16 v[168:171], a[140:143], v[104:107], v[168:171]
    v_mfma_f32_16x16x32_bf16 v[184:187], a[144:147], v[104:107], v[184:187]
    v_mfma_f32_16x16x32_bf16 v[200:203], a[148:151], v[104:107], v[200:203]
    v_mfma_f32_16x16x32_bf16 v[216:219], a[152:155], v[104:107], v[216:219]
    v_mfma_f32_16x16x32_bf16 v[232:235], a[156:159], v[104:107], v[232:235]
    s_waitcnt vmcnt(5)
    v_mfma_f32_16x16x32_bf16 v[168:171], a[160:163], v[108:111], v[168:171]
    v_mfma_f32_16x16x32_bf16 v[184:187], a[164:167], v[108:111], v[184:187]
    v_mfma_f32_16x16x32_bf16 v[200:203], a[168:171], v[108:111], v[200:203]
    v_mfma_f32_16x16x32_bf16 v[216:219], a[172:175], v[108:111], v[216:219]
    v_mfma_f32_16x16x32_bf16 v[232:235], a[176:179], v[108:111], v[232:235]
    s_waitcnt vmcnt(4)
    v_mfma_f32_16x16x32_bf16 v[168:171], a[180:183], v[112:115], v[168:171]
    v_mfma_f32_16x16x32_bf16 v[184:187], a[184:187], v[112:115], v[184:187]
    v_mfma_f32_16x16x32_bf16 v[200:203], a[188:191], v[112:115], v[200:203]
    v_mfma_f32_16x16x32_bf16 v[216:219], a[192:195], v[112:115], v[216:219]
    v_mfma_f32_16x16x32_bf16 v[232:235], a[196:199], v[112:115], v[232:235]
    s_waitcnt vmcnt(3)
    v_mfma_f32_16x16x32_bf16 v[168:171], a[200:203], v[116:119], v[168:171]
    v_mfma_f32_16x16x32_bf16 v[184:187], a[204:207], v[116:119], v[184:187]
    v_mfma_f32_16x16x32_bf16 v[200:203], a[208:211], v[116:119], v[200:203]
    v_mfma_f32_16x16x32_bf16 v[216:219], a[212:215], v[116:119], v[216:219]
    v_mfma_f32_16x16x32_bf16 v[232:235], a[216:219], v[116:119], v[232:235]
    s_waitcnt vmcnt(2)
    v_mfma_f32_16x16x32_bf16 v[168:171], a[220:223], v[120:123], v[168:171]
    v_mfma_f32_16x16x32_bf16 v[184:187], a[224:227], v[120:123], v[184:187]
    v_mfma_f32_16x16x32_bf16 v[200:203], a[228:231], v[120:123], v[200:203]
    v_mfma_f32_16x16x32_bf16 v[216:219], a[232:235], v[120:123], v[216:219]
    v_mfma_f32_16x16x32_bf16 v[232:235], a[236:239], v[120:123], v[232:235]
    s_waitcnt vmcnt(1)
    v_mfma_f32_16x16x32_bf16 v[168:171], a[240:243], v[124:127], v[168:171]
    v_mfma_f32_16x16x32_bf16 v[184:187], a[244:247], v[124:127], v[184:187]
    v_mfma_f32_16x16x32_bf16 v[200:203], a[248:251], v[124:127], v[200:203]
    v_mfma_f32_16x16x32_bf16 v[216:219], a[252:255], v[124:127], v[216:219]
    v_mfma_f32_16x16x32_bf16 v[232:235], v[26:29], v[124:127], v[232:235]
    s_waitcnt vmcnt(0)
    v_mfma_f32_16x16x32_bf16 v[168:171], v[30:33], v[128:131], v[168:171]
    v_mfma_f32_16x16x32_bf16 v[184:187], v[34:37], v[128:131], v[184:187]
    v_mfma_f32_16x16x32_bf16 v[200:203], v[38:41], v[128:131], v[200:203]
    v_mfma_f32_16x16x32_bf16 v[216:219], v[42:45], v[128:131], v[216:219]
    v_mfma_f32_16x16x32_bf16 v[232:235], v[46:49], v[128:131], v[232:235]
    s_nop 3
    v_pk_add_f32 v[112:113], v[72:73], v[168:169]
    v_pk_add_f32 v[114:115], v[74:75], v[170:171]
    v_pk_add_f32 v[116:117], v[76:77], v[184:185]
    v_pk_add_f32 v[118:119], v[78:79], v[186:187]
    v_pk_add_f32 v[120:121], v[80:81], v[200:201]
    v_pk_add_f32 v[122:123], v[82:83], v[202:203]
    v_pk_add_f32 v[124:125], v[84:85], v[216:217]
    v_pk_add_f32 v[126:127], v[86:87], v[218:219]
    v_pk_add_f32 v[128:129], v[88:89], v[232:233]
    v_pk_add_f32 v[130:131], v[90:91], v[234:235]
    v_cvt_pk_bf16_f32 v132, v112, v113
    v_cvt_pk_bf16_f32 v142, v116, v117
    v_cvt_pk_bf16_f32 v152, v120, v121
    v_cvt_pk_bf16_f32 v133, v114, v115
    v_cvt_pk_bf16_f32 v143, v118, v119
    v_cvt_pk_bf16_f32 v153, v122, v123
    v_lshlrev_b32 v134, 16, v132
    v_lshlrev_b32 v144, 16, v142
    v_lshlrev_b32 v154, 16, v152
    v_and_b32 v135, 0xffff0000, v132
    v_and_b32 v145, 0xffff0000, v142
    v_and_b32 v155, 0xffff0000, v152
    v_lshlrev_b32 v136, 16, v133
    v_lshlrev_b32 v146, 16, v143
    v_lshlrev_b32 v156, 16, v153
    v_and_b32 v137, 0xffff0000, v133
    v_and_b32 v147, 0xffff0000, v143
    v_and_b32 v157, 0xffff0000, v153
    v_lshlrev_b32 v138, 16, v16
    v_lshlrev_b32 v148, 16, v18
    v_lshlrev_b32 v158, 16, v20
    v_and_b32 v139, 0xffff0000, v16
    v_and_b32 v149, 0xffff0000, v18
    v_and_b32 v159, 0xffff0000, v20
    v_lshlrev_b32 v140, 16, v17
    v_lshlrev_b32 v150, 16, v19
    v_lshlrev_b32 v160, 16, v21
    v_and_b32 v141, 0xffff0000, v17
    v_and_b32 v151, 0xffff0000, v19
    v_and_b32 v161, 0xffff0000, v21
    v_add_f32 v134, v134, v138
    v_add_f32 v144, v144, v148
    v_add_f32 v154, v154, v158
    v_add_f32 v135, v135, v139
    v_add_f32 v145, v145, v149
    v_add_f32 v155, v155, v159
    v_add_f32 v136, v136, v140
    v_add_f32 v146, v146, v150
    v_add_f32 v156, v156, v160
    v_add_f32 v137, v137, v141
    v_add_f32 v147, v147, v151
    v_add_f32 v157, v157, v161
    v_cvt_pk_bf16_f32 v52, v134, v135
    v_cvt_pk_bf16_f32 v54, v144, v145
    v_cvt_pk_bf16_f32 v56, v154, v155
    v_cvt_pk_bf16_f32 v53, v136, v137
    v_cvt_pk_bf16_f32 v55, v146, v147
    v_cvt_pk_bf16_f32 v57, v156, v157
    v_cvt_pk_bf16_f32 v132, v124, v125
    v_cvt_pk_bf16_f32 v142, v128, v129
    v_cvt_pk_bf16_f32 v133, v126, v127
    v_cvt_pk_bf16_f32 v143, v130, v131
    v_lshlrev_b32 v134, 16, v132
    v_lshlrev_b32 v144, 16, v142
    v_and_b32 v135, 0xffff0000, v132
    v_and_b32 v145, 0xffff0000, v142
    v_lshlrev_b32 v136, 16, v133
    v_lshlrev_b32 v146, 16, v143
    v_and_b32 v137, 0xffff0000, v133
    v_and_b32 v147, 0xffff0000, v143
    v_lshlrev_b32 v138, 16, v22
    v_lshlrev_b32 v148, 16, v24
    v_and_b32 v139, 0xffff0000, v22
    v_and_b32 v149, 0xffff0000, v24
    v_lshlrev_b32 v140, 16, v23
    v_lshlrev_b32 v150, 16, v25
    v_and_b32 v141, 0xffff0000, v23
    v_and_b32 v151, 0xffff0000, v25
    v_add_f32 v134, v134, v138
    v_add_f32 v144, v144, v148
    v_add_f32 v135, v135, v139
    v_add_f32 v145, v145, v149
    v_add_f32 v136, v136, v140
    v_add_f32 v146, v146, v150
    v_add_f32 v137, v137, v141
    v_add_f32 v147, v147, v151
    v_cvt_pk_bf16_f32 v58, v134, v135
    v_cvt_pk_bf16_f32 v60, v144, v145
    v_cvt_pk_bf16_f32 v59, v136, v137
    v_cvt_pk_bf16_f32 v61, v146, v147
    s_cmp_eq_u32 s19, 0
    s_cbranch_scc1 D_slow16
    buffer_store_dwordx2 v[52:53], v14, s[28:31], s55 offen offset:0
    buffer_store_dwordx2 v[54:55], v14, s[28:31], s55 offen offset:32
    buffer_store_dwordx2 v[56:57], v14, s[28:31], s55 offen offset:64
    buffer_store_dwordx2 v[58:59], v14, s[28:31], s55 offen offset:96
    buffer_store_dwordx2 v[60:61], v14, s[28:31], s55 offen offset:128
    s_branch D_end16
D_slow16:
    buffer_store_dwordx2 v[52:53], v14, s[28:31], s55 offen offset:0 sc1
    buffer_store_dwordx2 v[54:55], v14, s[28:31], s55 offen offset:32 sc1
    buffer_store_dwordx2 v[56:57], v14, s[28:31], s55 offen offset:64 sc1
    buffer_store_dwordx2 v[58:59], v14, s[28:31], s55 offen offset:96 sc1
    buffer_store_dwordx2 v[60:61], v14, s[28:31], s55 offen offset:128 sc1
D_end16:
    s_cmp_lg_u32 s51, 0
    s_cbranch_scc1 F_end
    s_waitcnt vmcnt(0)
    s_barrier
    s_cmp_lg_u32 s50, 0
    s_cbranch_scc1 F_sig2
    s_add_u32 s57, s56, 4096
    s_lshl_b32 s58, s49, 2
    s_add_u32 s57, s57, s58
    v_mov_b32 v12, 0
    v_mov_b32 v13, 1
    v_cmp_eq_u32 vcc, 0, v0
    s_nop 0
    s_and_saveexec_b64 s[58:59], vcc
    s_cmp_eq_u32 s19, 0
    s_cbranch_scc1 D_slow17
    buffer_store_dword v13, v12, s[24:27], s57 offen
    s_branch D_end17
D_slow17:
    buffer_store_dword v13, v12, s[24:27], s57 offen sc1
D_end17:
    s_mov_b64 exec, s[58:59]
F_sig2:
    s_lshr_b32 s46, s49, 3
    s_lshl_b32 s46, s46, 3
    s_lshl_b32 s46, 0xff, s46
    s_add_u32 s57, s56, 4096
    v_and_b32 v12, 15, v0
    v_lshlrev_b32 v12, 2, v12
    s_mov_b32 s58, 0
F_w2_poll:
    buffer_load_dword v13, v12, s[24:27], s57 offen sc1
    s_waitcnt vmcnt(0)
    v_cmp_ne_u32 vcc, 1, v13
    s_nop 1
    s_and_b32 s59, vcc_lo, s46
    s_cbranch_scc0 F_w2_ok
    s_sleep 1
    s_add_u32 s58, s58, 1
    s_cmp_lt_u32 s58, 200000
    s_cbranch_scc1 F_w2_poll
F_w2_ok:
    s_nop 7
    s_nop 7
    s_mov_b32 s51, 1
    s_mov_b32 s52, 20447232
    s_mov_b32 s53, 12582912
    s_mov_b32 s54, 33554432
    s_add_u32 s56, s56, 6144
    s_add_u32 s20, s16, 17825792
    s_addc_u32 s21, s17, 0
    s_and_b32 s21, s21, 0xffff
    s_mov_b32 s22, 2621440
    s_mov_b32 s23, 0x00020000
    s_mov_b32 s28, s6
    s_mov_b32 s29, s7
    s_and_b32 s29, s29, 0xffff
    s_mov_b32 s30, 2621440
    s_mov_b32 s31, 0x00020000
    s_branch F_layer
F_end:
F_done:
    s_endpgm
.section .rodata,"a"
.p2align 6
.amdhsa_kernel p_kernel
  .amdhsa_next_free_vgpr 96
  .amdhsa_next_free_sgpr 96
  .amdhsa_accum_offset 96
  .amdhsa_group_segment_fixed_size 0
  .amdhsa_kernarg_size 96
  .amdhsa_user_sgpr_count 2
  .amdhsa_user_sgpr_kernarg_segment_ptr 1
  .amdhsa_system_sgpr_workgroup_id_x 1
.end_amdhsa_kernel
.p2align 6
.amdhsa_kernel c_kernel
  .amdhsa_next_free_vgpr 160
  .amdhsa_next_free_sgpr 96
  .amdhsa_accum_offset 160
  .amdhsa_group_segment_fixed_size 0
  .amdhsa_kernarg_size 96
  .amdhsa_user_sgpr_count 2
  .amdhsa_user_sgpr_kernarg_segment_ptr 1
  .amdhsa_system_sgpr_workgroup_id_x 1
.end_amdhsa_kernel
.p2align 6
.amdhsa_kernel f_kernel
  .amdhsa_next_free_vgpr 512
  .amdhsa_next_free_sgpr 102
  .amdhsa_accum_offset 256
  .amdhsa_group_segment_fixed_size 0
  .amdhsa_kernarg_size 96
  .amdhsa_user_sgpr_count 2
  .amdhsa_user_sgpr_kernarg_segment_ptr 1
  .amdhsa_system_sgpr_workgroup_id_x 1
.end_amdhsa_kernel
```
